```python
import torch

def _softmax(x, axis=-1):
    return torch.softmax(x, dim=axis)

def _gelu(x):
    return torch.nn.functional.gelu(x, approximate='tanh')

def _silu(x):
    return torch.nn.functional.silu(x)

def _sigmoid(x):
    return torch.sigmoid(x)

def _layernorm(x, axis=-1, eps=1e-05):
    m = x.mean(dim=axis, keepdim=True)
    v = x.var(dim=axis, keepdim=True, unbiased=False)
    return (x - m) / torch.sqrt(v + eps)

def _scatter_add(tgt, idx, src, axis=0):
    return tgt.clone().index_add_(axis, idx, src)

def _segment_sum(src, seg, n):
    out = torch.zeros((n,) + src.shape[1:], dtype=src.dtype)
    return out.index_add_(0, seg, src)

def _pad(x, pw):
    flat = tuple((v for pair in reversed(pw) for v in pair))
    return torch.nn.functional.pad(x, flat)
kernel_name = 'adaLN_cond__sliding_block__geglu_ffn__prompt'

def setup_inputs():

    _w = lambda a: (lambda t: t.to(torch.bfloat16) if t.is_floating_point() else t)(torch.as_tensor(a))

    def _A_setup():
        B, S, D = (1, 2048, 512)
        return {'x': _w((lambda *s: torch.randn(*s, dtype=torch.bfloat16) * 0.05)(B, S, D)), 'wqkv': _w((lambda *s: torch.randn(*s, dtype=torch.bfloat16) * 0.05)(D, 3 * D)), 'wo': _w((lambda *s: torch.randn(*s, dtype=torch.bfloat16) * 0.05)(D, D))}
    _A_in = _A_setup()

    def _B_setup():
        B, S, D, F = (1, 2048, 512, 1792)
        return {'x': _w((lambda *s: torch.randn(*s, dtype=torch.bfloat16) * 0.05)(B, S, D)), 'w_gate': _w((lambda *s: torch.randn(*s, dtype=torch.bfloat16) * 0.05)(D, F)), 'w_up': _w((lambda *s: torch.randn(*s, dtype=torch.bfloat16) * 0.05)(D, F)), 'w_down': _w((lambda *s: torch.randn(*s, dtype=torch.bfloat16) * 0.05)(F, D))}
    _B_in = _B_setup()
    return {'A_x': _A_in['x'], 'A_wqkv': _A_in['wqkv'], 'A_wo': _A_in['wo'], 'B_x': _B_in['x'], 'B_w_gate': _B_in['w_gate'], 'B_w_up': _B_in['w_up'], 'B_w_down': _B_in['w_down'], 'c': _w((lambda *s: torch.randn(*s, dtype=torch.bfloat16) * 0.1)(1, 512) * 8.0), 'w_mod': _w((lambda *s: torch.randn(*s, dtype=torch.bfloat16) * 0.1)(512, 6 * 512) * 512 ** (-0.5) * 8.0)}

def reference(A_x, A_wqkv, A_wo, B_x, B_w_gate, B_w_up, B_w_down, c, w_mod):

    def _A_ref(x, wqkv, wo):
        B, S, D = x.shape
        H = 32
        Dh = D // H
        W = 256
        qkv = (lambda x, *d: x.permute(*d))((x @ wqkv).reshape(B, S, 3, H, Dh), 2, 0, 3, 1, 4)
        q, k, v = (qkv[0], qkv[1], qkv[2])
        scores = torch.einsum('bhqd,bhkd->bhqk', q, k) * Dh ** (-0.5)
        idx = torch.arange(S)
        mask = (idx[:, None] - idx[None, :] >= 0) & (idx[:, None] - idx[None, :] < W)
        scores = torch.where(mask[None, None], scores, -1000000000.0)
        p = _softmax(scores, axis=-1)
        o = torch.einsum('bhqk,bhkd->bhqd', p, v)
        return (lambda x, *d: x.permute(*d))(o, 0, 2, 1, 3).reshape(B, S, D) @ wo

    def _B_ref(x, w_gate, w_up, w_down):
        return _gelu(x @ w_gate) * (x @ w_up) @ w_down
    x = A_x
    mod = (_silu(c) @ w_mod).reshape(c.shape[0], 6, 1, -1)
    sa, ca, ga, sb, cb, gb = (mod[:, 0].clone(), mod[:, 1].clone(), mod[:, 2].clone(), mod[:, 3].clone(), mod[:, 4].clone(), mod[:, 5].clone())
    h = _layernorm(x, axis=-1) * (1 + ca) + sa
    x = x + ga * _A_ref(h, A_wqkv, A_wo)
    h = _layernorm(x, axis=-1) * (1 + cb) + sb
    x = x + gb * _B_ref(h, B_w_gate, B_w_up, B_w_down)
    return x
```

```asm
; @launch grid=(256,1,1) block=(512,1,1) lds=163840
.amdgcn_target "amdgcn-amd-amdhsa--gfx950"
.text
.globl adaLN_cond__sliding_block__geglu_ffn__prompt_kernel
.p2align 8
.type adaLN_cond__sliding_block__geglu_ffn__prompt_kernel,@function
adaLN_cond__sliding_block__geglu_ffn__prompt_kernel:
s_cmp_ge_u32 s2, 256
s_cbranch_scc1 L_END
s_load_dwordx2 s[44:45], s[0:1], 88
s_load_dwordx2 s[36:37], s[0:1], 64
s_load_dwordx2 s[32:33], s[0:1], 56
s_load_dwordx2 s[8:9], s[0:1], 0
s_load_dwordx2 s[12:13], s[0:1], 8
s_load_dwordx2 s[16:17], s[0:1], 16
s_load_dwordx2 s[20:21], s[0:1], 32
s_load_dwordx2 s[24:25], s[0:1], 40
s_load_dwordx2 s[28:29], s[0:1], 48
s_load_dwordx2 s[40:41], s[0:1], 72
s_getpc_b64 s[60:61]
L_PC:
s_and_b32 s48, s2, 7
s_lshr_b32 s49, s2, 3
s_lshl_b32 s62, s49, 11
v_lshlrev_b32 v2, 2, v0
v_add_u32 v2, s62, v2
v_min_u32 v2, L_CODE_END-L_PC-4, v2
global_load_dword v4, v2, s[60:61]
s_getreg_b32 s54, hwreg(HW_REG_XCC_ID)
s_and_b32 s54, s54, 15
s_lshr_b32 s60, s49, 4
s_lshl_b32 s50, s48, 1
s_add_u32 s50, s50, s60
s_and_b32 s51, s49, 15
s_lshl_b32 s56, s48, 5
s_add_u32 s56, s56, s49
v_and_b32 v1, 63, v0
v_lshrrev_b32 v2, 6, v0
v_lshrrev_b32 v3, 4, v1
v_readfirstlane_b32 s52, v2
v_lshlrev_b32 v11, 4, v1
v_lshlrev_b32 v10, 7, v1
s_and_b32 s57, s52, 3
s_lshr_b32 s58, s52, 2
s_mov_b32 s55, 0
s_mov_b32 s10, 2097152
s_mov_b32 s11, 0x20000
s_mov_b32 s14, 1572864
s_mov_b32 s15, 0x20000
s_mov_b32 s18, 524288
s_mov_b32 s19, 0x20000
s_mov_b32 s22, 1835008
s_mov_b32 s23, 0x20000
s_mov_b32 s26, 1835008
s_mov_b32 s27, 0x20000
s_mov_b32 s30, 1835008
s_mov_b32 s31, 0x20000
s_mov_b32 s34, 1024
s_mov_b32 s35, 0x20000
s_mov_b32 s38, 3145728
s_mov_b32 s39, 0x20000
s_mov_b32 s42, 2097152
s_mov_b32 s43, 0x20000
s_mov_b32 s46, 268435456
s_mov_b32 s47, 0x20000
s_waitcnt lgkmcnt(0)
s_load_dword s53, s[44:45], 0
s_cmp_lt_u32 s52, 4
s_cbranch_scc1 Lw03_4
s_cmp_ge_u32 s52, 6
s_cbranch_scc1 Lw67_2
Lw45_1:
s_cmp_ge_u32 s49, 20
s_cbranch_scc1 L_NOGEMV
v_lshrrev_b32 v12, 3, v1
v_mul_u32_u24 v12, 6144, v12
v_and_b32 v2, 7, v1
v_bfe_u32 v13, v1, 4, 1
v_lshlrev_b32 v13, 2, v13
v_xor_b32 v2, v2, v13
v_lshl_add_u32 v12, v2, 4, v12
s_lshl_b32 s60, s49, 7
s_lshl_b32 s61, s48, 9
s_add_u32 s61, s61, s60
s_cmp_ge_u32 s49, 16
s_cselect_b32 s60, s61, s60
s_mul_i32 s61, s57, 1572864
s_add_u32 s60, s60, s61
s_lshl_b32 s62, s57, 15
s_lshl_b32 s64, s57, 9
v_lshlrev_b32 v8, 3, v1
buffer_load_dwordx2 v[70:71], v8, s[32:35], s64 offen
s_mov_b32 s65, 0
s_add_u32 s66, s62, 98304
Lsd_5:
s_add_u32 m0, s66, 0
s_add_u32 s63, s60, 0
buffer_load_dwordx4 v12, s[36:39], s63 offen lds
s_add_u32 m0, s66, 1024
s_add_u32 s63, s60, 49152
buffer_load_dwordx4 v12, s[36:39], s63 offen lds
s_add_u32 m0, s66, 2048
s_add_u32 s63, s60, 98304
buffer_load_dwordx4 v12, s[36:39], s63 offen lds
s_add_u32 m0, s66, 3072
s_add_u32 s63, s60, 147456
buffer_load_dwordx4 v12, s[36:39], s63 offen lds
s_add_u32 s66, s66, 4096
s_add_u32 s60, s60, 196608
s_add_u32 s65, s65, 1
s_cmp_lt_u32 s65, 8
s_cbranch_scc1 Lsd_5
s_waitcnt lgkmcnt(0)
s_mul_i32 s53, s53, 1664525
s_add_u32 s53, s53, 1013904223
s_lshl_b32 s64, s57, 2
v_mov_b32 v13, s64
v_mov_b32 v14, s53
ds_write_b32 v13, v14 offset:32760
s_branch L_GEMV2
Lw67_2:
v_lshrrev_b32 v12, 2, v1
v_mul_u32_u24 v12, 3072, v12
v_and_b32 v13, 3, v1
v_lshl_add_u32 v12, v13, 4, v12
s_waitcnt lgkmcnt(0)
s_mul_i32 s53, s53, 1664525
s_add_u32 s53, s53, 1013904223
v_mov_b32 v14, s54
v_mov_b32 v15, s53
s_lshl_b32 s60, s56, 3
s_add_u32 s60, s60, 4096
v_mov_b32 v13, 0
s_mov_b64 exec, 1
buffer_store_dwordx2 v[14:15], v13, s[44:47], s60 offen sc1
s_mov_b64 exec, -1
s_and_b32 s64, s52, 1
s_mul_i32 s60, s64, 49152
s_lshl_b32 s61, s51, 6
s_add_u32 s60, s60, s61
s_lshl_b32 s62, s64, 10
s_cmp_ge_u32 s49, 20
s_cbranch_scc1 Lgateo_7
v_and_b32 v13, 1, v1
v_lshlrev_b32 v13, 2, v13
s_mov_b32 s71, 0
Lgate_6:
ds_read_b32 v14, v13 offset:32760
s_add_u32 s71, s71, 1
s_cmp_gt_u32 s71, 4000000
s_cbranch_scc1 Lgateo_7
s_waitcnt lgkmcnt(0)
v_cmp_ne_u32 vcc, s53, v14
s_nop 0
s_cbranch_vccnz Lgate_6
Lgateo_7:
s_waitcnt lgkmcnt(0)
s_mov_b32 s65, 0
Lqd_8:
s_add_u32 m0, s62, 0
s_add_u32 s63, s60, 0
buffer_load_dwordx4 v12, s[12:15], s63 offen lds
s_add_u32 m0, s62, 32768
s_add_u32 s63, s60, 1024
buffer_load_dwordx4 v12, s[12:15], s63 offen lds
s_add_u32 m0, s62, 65536
s_add_u32 s63, s60, 2048
buffer_load_dwordx4 v12, s[12:15], s63 offen lds
s_add_u32 s62, s62, 2048
s_add_u32 s60, s60, 98304
s_add_u32 s65, s65, 1
s_cmp_lt_u32 s65, 16
s_cbranch_scc1 Lqd_8
s_waitcnt vmcnt(0)
s_branch Lj0_3
Lw03_4:
s_lshl_b32 s60, s50, 17
s_lshl_b32 s61, s51, 13
s_add_u32 s60, s60, s61
s_and_b32 s61, s52, 1
s_lshl_b32 s61, s61, 12
s_add_u32 s60, s60, s61
s_sub_u32 s61, s60, 262144
s_cmp_lt_u32 s50, 2
s_cselect_b32 s61, s60, s61
s_cmp_ge_u32 s52, 2
s_cselect_b32 s60, s61, s60
buffer_load_dwordx4 v[16:19], v11, s[8:11], s60 offen offset:0
buffer_load_dwordx4 v[20:23], v11, s[8:11], s60 offen offset:1024
buffer_load_dwordx4 v[24:27], v11, s[8:11], s60 offen offset:2048
buffer_load_dwordx4 v[28:31], v11, s[8:11], s60 offen offset:3072
v_lshrrev_b32 v5, 2, v1
v_and_b32 v6, 3, v1
s_cmp_eq_u32 s52, 0
s_cbranch_scc1 Lc30_9
s_cmp_eq_u32 s52, 1
s_cbranch_scc1 Lc31_10
s_cmp_lg_u32 s52, 2
s_cbranch_scc1 Lc33_12
v_and_b32 v5, 15, v1
v_lshlrev_b32 v5, 10, v5
s_lshl_b32 s62, s49, 14
buffer_load_dword v6, v5, s[16:19], s62 offen offset:384
s_branch Lc3e_11
Lc30_9:
v_mul_u32_u24 v5, 6144, v5
v_and_b32 v6, 1, v6
v_lshl_add_u32 v5, v6, 10, v5
s_mul_i32 s62, s49, 98304
buffer_load_dword v6, v5, s[36:39], s62 offen offset:384
s_branch Lc3e_11
Lc31_10:
v_mul_u32_u24 v5, 3072, v5
v_lshl_add_u32 v5, v6, 10, v5
s_mul_i32 s62, s49, 49152
buffer_load_dword v6, v5, s[12:15], s62 offen offset:384
s_branch Lc3e_11
Lc33_12:
Lc3e_11:
s_waitcnt vmcnt(0)
s_waitcnt lgkmcnt(0)
s_mul_i32 s53, s53, 1664525
s_add_u32 s53, s53, 1013904223
v_lshlrev_b32 v32, 16, v16
v_and_b32 v33, 0xffff0000, v16
v_lshlrev_b32 v34, 16, v17
v_and_b32 v35, 0xffff0000, v17
v_lshlrev_b32 v36, 16, v18
v_and_b32 v37, 0xffff0000, v18
v_lshlrev_b32 v38, 16, v19
v_and_b32 v39, 0xffff0000, v19
v_lshlrev_b32 v40, 16, v20
v_and_b32 v41, 0xffff0000, v20
v_lshlrev_b32 v42, 16, v21
v_and_b32 v43, 0xffff0000, v21
v_lshlrev_b32 v44, 16, v22
v_and_b32 v45, 0xffff0000, v22
v_lshlrev_b32 v46, 16, v23
v_and_b32 v47, 0xffff0000, v23
v_lshlrev_b32 v48, 16, v24
v_and_b32 v49, 0xffff0000, v24
v_lshlrev_b32 v50, 16, v25
v_and_b32 v51, 0xffff0000, v25
v_lshlrev_b32 v52, 16, v26
v_and_b32 v53, 0xffff0000, v26
v_lshlrev_b32 v54, 16, v27
v_and_b32 v55, 0xffff0000, v27
v_lshlrev_b32 v56, 16, v28
v_and_b32 v57, 0xffff0000, v28
v_lshlrev_b32 v58, 16, v29
v_and_b32 v59, 0xffff0000, v29
v_lshlrev_b32 v60, 16, v30
v_and_b32 v61, 0xffff0000, v30
v_lshlrev_b32 v62, 16, v31
v_and_b32 v63, 0xffff0000, v31
v_add_f32 v64, v32, v33
v_add_f32 v64, v64, v34
v_add_f32 v64, v64, v35
v_add_f32 v64, v64, v36
v_add_f32 v64, v64, v37
v_add_f32 v64, v64, v38
v_add_f32 v64, v64, v39
v_add_f32 v65, v40, v41
v_add_f32 v65, v65, v42
v_add_f32 v65, v65, v43
v_add_f32 v65, v65, v44
v_add_f32 v65, v65, v45
v_add_f32 v65, v65, v46
v_add_f32 v65, v65, v47
v_add_f32 v66, v48, v49
v_add_f32 v66, v66, v50
v_add_f32 v66, v66, v51
v_add_f32 v66, v66, v52
v_add_f32 v66, v66, v53
v_add_f32 v66, v66, v54
v_add_f32 v66, v66, v55
v_add_f32 v67, v56, v57
v_add_f32 v67, v67, v58
v_add_f32 v67, v67, v59
v_add_f32 v67, v67, v60
v_add_f32 v67, v67, v61
v_add_f32 v67, v67, v62
v_add_f32 v67, v67, v63
v_add_f32_dpp v64, v64, v64 row_ror:1 row_mask:0xf bank_mask:0xf
v_add_f32_dpp v65, v65, v65 row_ror:1 row_mask:0xf bank_mask:0xf
v_add_f32_dpp v66, v66, v66 row_ror:1 row_mask:0xf bank_mask:0xf
v_add_f32_dpp v67, v67, v67 row_ror:1 row_mask:0xf bank_mask:0xf
v_add_f32_dpp v64, v64, v64 row_ror:2 row_mask:0xf bank_mask:0xf
v_add_f32_dpp v65, v65, v65 row_ror:2 row_mask:0xf bank_mask:0xf
v_add_f32_dpp v66, v66, v66 row_ror:2 row_mask:0xf bank_mask:0xf
v_add_f32_dpp v67, v67, v67 row_ror:2 row_mask:0xf bank_mask:0xf
v_add_f32_dpp v64, v64, v64 row_ror:4 row_mask:0xf bank_mask:0xf
v_add_f32_dpp v65, v65, v65 row_ror:4 row_mask:0xf bank_mask:0xf
v_add_f32_dpp v66, v66, v66 row_ror:4 row_mask:0xf bank_mask:0xf
v_add_f32_dpp v67, v67, v67 row_ror:4 row_mask:0xf bank_mask:0xf
v_add_f32_dpp v64, v64, v64 row_ror:8 row_mask:0xf bank_mask:0xf
v_add_f32_dpp v65, v65, v65 row_ror:8 row_mask:0xf bank_mask:0xf
v_add_f32_dpp v66, v66, v66 row_ror:8 row_mask:0xf bank_mask:0xf
v_add_f32_dpp v67, v67, v67 row_ror:8 row_mask:0xf bank_mask:0xf
v_mov_b32 v68, v64
v_mov_b32 v69, v65
v_mov_b32 v70, v66
v_mov_b32 v71, v67
v_permlane16_swap_b32 v64, v68
v_permlane16_swap_b32 v65, v69
v_permlane16_swap_b32 v66, v70
v_permlane16_swap_b32 v67, v71
v_add_f32 v64, v64, v68
v_add_f32 v65, v65, v69
v_add_f32 v66, v66, v70
v_add_f32 v67, v67, v71
v_mov_b32 v68, v64
v_mov_b32 v69, v65
v_mov_b32 v70, v66
v_mov_b32 v71, v67
v_permlane32_swap_b32 v64, v68
v_permlane32_swap_b32 v65, v69
v_permlane32_swap_b32 v66, v70
v_permlane32_swap_b32 v67, v71
v_add_f32 v64, v64, v68
v_add_f32 v65, v65, v69
v_add_f32 v66, v66, v70
v_add_f32 v67, v67, v71
v_mul_f32 v64, 0xbb000000, v64
v_mul_f32 v65, 0xbb000000, v65
v_mul_f32 v66, 0xbb000000, v66
v_mul_f32 v67, 0xbb000000, v67
v_add_f32 v32, v64, v32
v_add_f32 v33, v64, v33
v_add_f32 v34, v64, v34
v_add_f32 v35, v64, v35
v_add_f32 v36, v64, v36
v_add_f32 v37, v64, v37
v_add_f32 v38, v64, v38
v_add_f32 v39, v64, v39
v_add_f32 v40, v65, v40
v_add_f32 v41, v65, v41
v_add_f32 v42, v65, v42
v_add_f32 v43, v65, v43
v_add_f32 v44, v65, v44
v_add_f32 v45, v65, v45
v_add_f32 v46, v65, v46
v_add_f32 v47, v65, v47
v_add_f32 v48, v66, v48
v_add_f32 v49, v66, v49
v_add_f32 v50, v66, v50
v_add_f32 v51, v66, v51
v_add_f32 v52, v66, v52
v_add_f32 v53, v66, v53
v_add_f32 v54, v66, v54
v_add_f32 v55, v66, v55
v_add_f32 v56, v67, v56
v_add_f32 v57, v67, v57
v_add_f32 v58, v67, v58
v_add_f32 v59, v67, v59
v_add_f32 v60, v67, v60
v_add_f32 v61, v67, v61
v_add_f32 v62, v67, v62
v_add_f32 v63, v67, v63
v_mul_f32 v64, v32, v32
v_fmac_f32 v64, v33, v33
v_fmac_f32 v64, v34, v34
v_fmac_f32 v64, v35, v35
v_fmac_f32 v64, v36, v36
v_fmac_f32 v64, v37, v37
v_fmac_f32 v64, v38, v38
v_fmac_f32 v64, v39, v39
v_mul_f32 v65, v40, v40
v_fmac_f32 v65, v41, v41
v_fmac_f32 v65, v42, v42
v_fmac_f32 v65, v43, v43
v_fmac_f32 v65, v44, v44
v_fmac_f32 v65, v45, v45
v_fmac_f32 v65, v46, v46
v_fmac_f32 v65, v47, v47
v_mul_f32 v66, v48, v48
v_fmac_f32 v66, v49, v49
v_fmac_f32 v66, v50, v50
v_fmac_f32 v66, v51, v51
v_fmac_f32 v66, v52, v52
v_fmac_f32 v66, v53, v53
v_fmac_f32 v66, v54, v54
v_fmac_f32 v66, v55, v55
v_mul_f32 v67, v56, v56
v_fmac_f32 v67, v57, v57
v_fmac_f32 v67, v58, v58
v_fmac_f32 v67, v59, v59
v_fmac_f32 v67, v60, v60
v_fmac_f32 v67, v61, v61
v_fmac_f32 v67, v62, v62
v_fmac_f32 v67, v63, v63
v_add_f32_dpp v64, v64, v64 row_ror:1 row_mask:0xf bank_mask:0xf
v_add_f32_dpp v65, v65, v65 row_ror:1 row_mask:0xf bank_mask:0xf
v_add_f32_dpp v66, v66, v66 row_ror:1 row_mask:0xf bank_mask:0xf
v_add_f32_dpp v67, v67, v67 row_ror:1 row_mask:0xf bank_mask:0xf
v_add_f32_dpp v64, v64, v64 row_ror:2 row_mask:0xf bank_mask:0xf
v_add_f32_dpp v65, v65, v65 row_ror:2 row_mask:0xf bank_mask:0xf
v_add_f32_dpp v66, v66, v66 row_ror:2 row_mask:0xf bank_mask:0xf
v_add_f32_dpp v67, v67, v67 row_ror:2 row_mask:0xf bank_mask:0xf
v_add_f32_dpp v64, v64, v64 row_ror:4 row_mask:0xf bank_mask:0xf
v_add_f32_dpp v65, v65, v65 row_ror:4 row_mask:0xf bank_mask:0xf
v_add_f32_dpp v66, v66, v66 row_ror:4 row_mask:0xf bank_mask:0xf
v_add_f32_dpp v67, v67, v67 row_ror:4 row_mask:0xf bank_mask:0xf
v_add_f32_dpp v64, v64, v64 row_ror:8 row_mask:0xf bank_mask:0xf
v_add_f32_dpp v65, v65, v65 row_ror:8 row_mask:0xf bank_mask:0xf
v_add_f32_dpp v66, v66, v66 row_ror:8 row_mask:0xf bank_mask:0xf
v_add_f32_dpp v67, v67, v67 row_ror:8 row_mask:0xf bank_mask:0xf
v_mov_b32 v68, v64
v_mov_b32 v69, v65
v_mov_b32 v70, v66
v_mov_b32 v71, v67
v_permlane16_swap_b32 v64, v68
v_permlane16_swap_b32 v65, v69
v_permlane16_swap_b32 v66, v70
v_permlane16_swap_b32 v67, v71
v_add_f32 v64, v64, v68
v_add_f32 v65, v65, v69
v_add_f32 v66, v66, v70
v_add_f32 v67, v67, v71
v_mov_b32 v68, v64
v_mov_b32 v69, v65
v_mov_b32 v70, v66
v_mov_b32 v71, v67
v_permlane32_swap_b32 v64, v68
v_permlane32_swap_b32 v65, v69
v_permlane32_swap_b32 v66, v70
v_permlane32_swap_b32 v67, v71
v_add_f32 v64, v64, v68
v_add_f32 v65, v65, v69
v_add_f32 v66, v66, v70
v_add_f32 v67, v67, v71
v_mul_f32 v64, 0x3b000000, v64
v_mul_f32 v65, 0x3b000000, v65
v_mul_f32 v66, 0x3b000000, v66
v_mul_f32 v67, 0x3b000000, v67
v_add_f32 v64, 0x3727c5ac, v64
v_add_f32 v65, 0x3727c5ac, v65
v_add_f32 v66, 0x3727c5ac, v66
v_add_f32 v67, 0x3727c5ac, v67
v_rsq_f32 v64, v64
v_rsq_f32 v65, v65
v_rsq_f32 v66, v66
v_rsq_f32 v67, v67
v_mul_f32 v32, v64, v32
v_mul_f32 v33, v64, v33
v_mul_f32 v34, v64, v34
v_mul_f32 v35, v64, v35
v_mul_f32 v36, v64, v36
v_mul_f32 v37, v64, v37
v_mul_f32 v38, v64, v38
v_mul_f32 v39, v64, v39
v_mul_f32 v40, v65, v40
v_mul_f32 v41, v65, v41
v_mul_f32 v42, v65, v42
v_mul_f32 v43, v65, v43
v_mul_f32 v44, v65, v44
v_mul_f32 v45, v65, v45
v_mul_f32 v46, v65, v46
v_mul_f32 v47, v65, v47
v_mul_f32 v48, v66, v48
v_mul_f32 v49, v66, v49
v_mul_f32 v50, v66, v50
v_mul_f32 v51, v66, v51
v_mul_f32 v52, v66, v52
v_mul_f32 v53, v66, v53
v_mul_f32 v54, v66, v54
v_mul_f32 v55, v66, v55
v_mul_f32 v56, v67, v56
v_mul_f32 v57, v67, v57
v_mul_f32 v58, v67, v58
v_mul_f32 v59, v67, v59
v_mul_f32 v60, v67, v60
v_mul_f32 v61, v67, v61
v_mul_f32 v62, v67, v62
v_mul_f32 v63, v67, v63
v_cvt_pk_bf16_f32 v16, v32, v33
v_cvt_pk_bf16_f32 v17, v34, v35
v_cvt_pk_bf16_f32 v18, v36, v37
v_cvt_pk_bf16_f32 v19, v38, v39
v_cvt_pk_bf16_f32 v20, v40, v41
v_cvt_pk_bf16_f32 v21, v42, v43
v_cvt_pk_bf16_f32 v22, v44, v45
v_cvt_pk_bf16_f32 v23, v46, v47
v_cvt_pk_bf16_f32 v24, v48, v49
v_cvt_pk_bf16_f32 v25, v50, v51
v_cvt_pk_bf16_f32 v26, v52, v53
v_cvt_pk_bf16_f32 v27, v54, v55
v_cvt_pk_bf16_f32 v28, v56, v57
v_cvt_pk_bf16_f32 v29, v58, v59
v_cvt_pk_bf16_f32 v30, v60, v61
v_cvt_pk_bf16_f32 v31, v62, v63
v_lshlrev_b32 v32, 16, v16
v_and_b32 v33, 0xffff0000, v16
v_lshlrev_b32 v34, 16, v17
v_and_b32 v35, 0xffff0000, v17
v_lshlrev_b32 v36, 16, v18
v_and_b32 v37, 0xffff0000, v18
v_lshlrev_b32 v38, 16, v19
v_and_b32 v39, 0xffff0000, v19
v_lshlrev_b32 v40, 16, v20
v_and_b32 v41, 0xffff0000, v20
v_lshlrev_b32 v42, 16, v21
v_and_b32 v43, 0xffff0000, v21
v_lshlrev_b32 v44, 16, v22
v_and_b32 v45, 0xffff0000, v22
v_lshlrev_b32 v46, 16, v23
v_and_b32 v47, 0xffff0000, v23
v_lshlrev_b32 v48, 16, v24
v_and_b32 v49, 0xffff0000, v24
v_lshlrev_b32 v50, 16, v25
v_and_b32 v51, 0xffff0000, v25
v_lshlrev_b32 v52, 16, v26
v_and_b32 v53, 0xffff0000, v26
v_lshlrev_b32 v54, 16, v27
v_and_b32 v55, 0xffff0000, v27
v_lshlrev_b32 v56, 16, v28
v_and_b32 v57, 0xffff0000, v28
v_lshlrev_b32 v58, 16, v29
v_and_b32 v59, 0xffff0000, v29
v_lshlrev_b32 v60, 16, v30
v_and_b32 v61, 0xffff0000, v30
v_lshlrev_b32 v62, 16, v31
v_and_b32 v63, 0xffff0000, v31
v_lshrrev_b32 v12, 1, v1
v_lshlrev_b32 v12, 10, v12
v_and_b32 v6, 1, v1
v_lshl_add_u32 v12, v6, 9, v12
s_lshl_b32 s64, s48, 19
s_and_b32 s63, s50, 1
s_lshl_b32 s63, s63, 17
s_add_u32 s64, s64, s63
s_lshr_b32 s63, s51, 2
s_lshl_b32 s63, s63, 15
s_add_u32 s64, s64, s63
s_and_b32 s63, s51, 3
s_lshl_b32 s63, s63, 7
s_add_u32 s64, s64, s63
s_and_b32 s63, s52, 1
s_lshl_b32 s63, s63, 6
s_add_u32 s64, s64, s63
s_add_u32 s64, s64, 18874368
s_add_u32 s68, s64, 262144
s_cmp_ge_u32 s52, 2
s_cselect_b32 s64, s64, s68
v_lshlrev_b32 v13, 5, v1
v_lshlrev_b32 v7, 6, v1
v_add_u32 v7, 60, v7
v_and_b32 v8, 31, v1
v_lshlrev_b32 v8, 3, v8
s_lshl_b32 s60, s48, 12
s_add_u32 s61, s60, 40960
s_add_u32 s60, s60, 8192
s_lshl_b32 s62, s48, 8
s_add_u32 s62, s62, 4096
s_lshl_b32 s65, s56, 4
s_lshl_b32 s66, s52, 2
s_add_u32 s65, s65, s66
s_add_u32 s65, s65, 139264
s_mov_b32 s71, 0
G_13:
buffer_load_dword v96, v7, s[44:47], s60 offen sc1
s_add_u32 s71, s71, 1
s_cmp_gt_u32 s71, 400000
s_cbranch_scc1 G2_14
s_waitcnt vmcnt(0)
v_cmp_ne_u32 vcc, s53, v96
s_nop 0
s_cbranch_vccz G2_14
s_add_u32 s70, s71, 1
s_and_b32 s70, s70, 15
s_cmp_lt_u32 s70, 2
s_cselect_b32 s70, s61, s60
s_cselect_b32 s61, s60, s61
s_mov_b32 s60, s70
s_sleep 6
s_branch G_13
G2_14:
buffer_load_dwordx4 v[96:99], v13, s[44:47], s60 offen sc1
buffer_load_dwordx4 v[100:103], v13, s[44:47], s60 offen offset:16 sc1
buffer_load_dwordx4 v[104:107], v13, s[44:47], s60 offen offset:2048 sc1
buffer_load_dwordx4 v[108:111], v13, s[44:47], s60 offen offset:2064 sc1
buffer_load_dwordx2 v[112:113], v8, s[44:47], s62 offen sc1
s_cmp_gt_u32 s71, 400000
s_cbranch_scc1 Go_15
s_waitcnt vmcnt(0)
v_xor_b32 v116, s53, v97
v_xor_b32 v117, s53, v99
v_or_b32 v116, v116, v117
v_xor_b32 v117, s53, v101
v_or_b32 v116, v116, v117
v_xor_b32 v117, s53, v103
v_or_b32 v116, v116, v117
v_xor_b32 v117, s53, v105
v_or_b32 v116, v116, v117
v_xor_b32 v117, s53, v107
v_or_b32 v116, v116, v117
v_xor_b32 v117, s53, v109
v_or_b32 v116, v116, v117
v_xor_b32 v117, s53, v111
v_or_b32 v116, v116, v117
v_cmp_ne_u32 vcc, 0, v116
s_nop 0
s_cbranch_vccnz G_13
Go_15:
s_waitcnt vmcnt(0)
v_xor_b32 v116, s53, v113
v_xor_b32 v117, s54, v112
v_or_b32 v116, v116, v117
v_cmp_ne_u32 vcc, 0, v116
s_nop 0
s_cmp_eq_u64 vcc, 0
s_cselect_b32 s55, 1, 0
v_lshlrev_b32 v72, 16, v96
v_and_b32 v73, 0xffff0000, v96
v_lshlrev_b32 v80, 16, v104
v_and_b32 v81, 0xffff0000, v104
v_lshlrev_b32 v74, 16, v98
v_and_b32 v75, 0xffff0000, v98
v_lshlrev_b32 v82, 16, v106
v_and_b32 v83, 0xffff0000, v106
v_lshlrev_b32 v76, 16, v100
v_and_b32 v77, 0xffff0000, v100
v_lshlrev_b32 v84, 16, v108
v_and_b32 v85, 0xffff0000, v108
v_lshlrev_b32 v78, 16, v102
v_and_b32 v79, 0xffff0000, v102
v_lshlrev_b32 v86, 16, v110
v_and_b32 v87, 0xffff0000, v110
v_pk_fma_f32 v[32:33], v[32:33], v[80:81], v[72:73]
v_pk_fma_f32 v[34:35], v[34:35], v[82:83], v[74:75]
v_pk_fma_f32 v[36:37], v[36:37], v[84:85], v[76:77]
v_pk_fma_f32 v[38:39], v[38:39], v[86:87], v[78:79]
v_cvt_pk_bf16_f32 v16, v32, v33
v_cvt_pk_bf16_f32 v17, v34, v35
v_cvt_pk_bf16_f32 v18, v36, v37
v_cvt_pk_bf16_f32 v19, v38, v39
v_pk_fma_f32 v[40:41], v[40:41], v[80:81], v[72:73]
v_pk_fma_f32 v[42:43], v[42:43], v[82:83], v[74:75]
v_pk_fma_f32 v[44:45], v[44:45], v[84:85], v[76:77]
v_pk_fma_f32 v[46:47], v[46:47], v[86:87], v[78:79]
v_cvt_pk_bf16_f32 v20, v40, v41
v_cvt_pk_bf16_f32 v21, v42, v43
v_cvt_pk_bf16_f32 v22, v44, v45
v_cvt_pk_bf16_f32 v23, v46, v47
v_pk_fma_f32 v[48:49], v[48:49], v[80:81], v[72:73]
v_pk_fma_f32 v[50:51], v[50:51], v[82:83], v[74:75]
v_pk_fma_f32 v[52:53], v[52:53], v[84:85], v[76:77]
v_pk_fma_f32 v[54:55], v[54:55], v[86:87], v[78:79]
v_cvt_pk_bf16_f32 v24, v48, v49
v_cvt_pk_bf16_f32 v25, v50, v51
v_cvt_pk_bf16_f32 v26, v52, v53
v_cvt_pk_bf16_f32 v27, v54, v55
v_pk_fma_f32 v[56:57], v[56:57], v[80:81], v[72:73]
v_pk_fma_f32 v[58:59], v[58:59], v[82:83], v[74:75]
v_pk_fma_f32 v[60:61], v[60:61], v[84:85], v[76:77]
v_pk_fma_f32 v[62:63], v[62:63], v[86:87], v[78:79]
v_cvt_pk_bf16_f32 v28, v56, v57
v_cvt_pk_bf16_f32 v29, v58, v59
v_cvt_pk_bf16_f32 v30, v60, v61
v_cvt_pk_bf16_f32 v31, v62, v63
v_mov_b32 v14, s53
v_mov_b32 v15, 0
s_cmp_eq_u32 s55, 0
s_cbranch_scc1 Ssl_16
buffer_store_dwordx4 v[16:19], v12, s[44:47], s64 offen offset:0
buffer_store_dwordx4 v[20:23], v12, s[44:47], s64 offen offset:16
buffer_store_dwordx4 v[24:27], v12, s[44:47], s64 offen offset:32
buffer_store_dwordx4 v[28:31], v12, s[44:47], s64 offen offset:48
s_waitcnt vmcnt(0)
s_mov_b64 exec, 1
buffer_store_dword v14, v15, s[44:47], s65 offen
s_mov_b64 exec, -1
s_branch Sen_17
Ssl_16:
buffer_store_dwordx4 v[16:19], v12, s[44:47], s64 offen offset:0 sc1
buffer_store_dwordx4 v[20:23], v12, s[44:47], s64 offen offset:16 sc1
buffer_store_dwordx4 v[24:27], v12, s[44:47], s64 offen offset:32 sc1
buffer_store_dwordx4 v[28:31], v12, s[44:47], s64 offen offset:48 sc1
s_waitcnt vmcnt(0)
s_mov_b64 exec, 1
buffer_store_dword v14, v15, s[44:47], s65 offen sc1
s_mov_b64 exec, -1
Sen_17:
s_branch Lj0_3
L_GEMV2:
s_waitcnt vmcnt(32)
v_lshlrev_b32 v14, 16, v70
v_and_b32 v15, 0xffff0000, v70
v_lshlrev_b32 v16, 16, v71
v_and_b32 v17, 0xffff0000, v71
v_mul_f32 v30, 0xbfb8aa3b, v14
v_mul_f32 v31, 0xbfb8aa3b, v15
v_mul_f32 v32, 0xbfb8aa3b, v16
v_mul_f32 v33, 0xbfb8aa3b, v17
v_exp_f32 v30, v30
v_exp_f32 v31, v31
v_exp_f32 v32, v32
v_exp_f32 v33, v33
v_add_f32 v30, 1.0, v30
v_add_f32 v31, 1.0, v31
v_add_f32 v32, 1.0, v32
v_add_f32 v33, 1.0, v33
v_rcp_f32 v30, v30
v_rcp_f32 v31, v31
v_rcp_f32 v32, v32
v_rcp_f32 v33, v33
v_mul_f32 v14, v14, v30
v_mul_f32 v15, v15, v31
v_mul_f32 v16, v16, v32
v_mul_f32 v17, v17, v33
v_cvt_pk_bf16_f32 v30, v14, v15
v_cvt_pk_bf16_f32 v31, v16, v17
v_lshlrev_b32 v14, 16, v30
v_and_b32 v15, 0xffff0000, v30
v_lshlrev_b32 v16, 16, v31
v_and_b32 v17, 0xffff0000, v31
v_lshrrev_b32 v9, 5, v1
v_lshlrev_b32 v9, 3, v9
ds_bpermute_b32 v94, v9, v30 offset:0
ds_bpermute_b32 v95, v9, v31 offset:0
ds_bpermute_b32 v96, v9, v30 offset:4
ds_bpermute_b32 v97, v9, v31 offset:4
ds_bpermute_b32 v98, v9, v30 offset:16
ds_bpermute_b32 v99, v9, v31 offset:16
ds_bpermute_b32 v100, v9, v30 offset:20
ds_bpermute_b32 v101, v9, v31 offset:20
ds_bpermute_b32 v102, v9, v30 offset:32
ds_bpermute_b32 v103, v9, v31 offset:32
ds_bpermute_b32 v104, v9, v30 offset:36
ds_bpermute_b32 v105, v9, v31 offset:36
s_waitcnt lgkmcnt(3)
ds_bpermute_b32 v106, v9, v30 offset:48
ds_bpermute_b32 v107, v9, v31 offset:48
ds_bpermute_b32 v108, v9, v30 offset:52
ds_bpermute_b32 v109, v9, v31 offset:52
ds_bpermute_b32 v110, v9, v30 offset:64
ds_bpermute_b32 v111, v9, v31 offset:64
ds_bpermute_b32 v112, v9, v30 offset:68
ds_bpermute_b32 v113, v9, v31 offset:68
ds_bpermute_b32 v114, v9, v30 offset:80
ds_bpermute_b32 v115, v9, v31 offset:80
ds_bpermute_b32 v116, v9, v30 offset:84
ds_bpermute_b32 v117, v9, v31 offset:84
s_waitcnt lgkmcnt(3)
ds_bpermute_b32 v118, v9, v30 offset:96
ds_bpermute_b32 v119, v9, v31 offset:96
ds_bpermute_b32 v120, v9, v30 offset:100
ds_bpermute_b32 v121, v9, v31 offset:100
ds_bpermute_b32 v122, v9, v30 offset:112
ds_bpermute_b32 v123, v9, v31 offset:112
ds_bpermute_b32 v124, v9, v30 offset:116
ds_bpermute_b32 v125, v9, v31 offset:116
ds_bpermute_b32 v126, v9, v30 offset:128
ds_bpermute_b32 v127, v9, v31 offset:128
ds_bpermute_b32 v128, v9, v30 offset:132
ds_bpermute_b32 v129, v9, v31 offset:132
s_waitcnt lgkmcnt(3)
ds_bpermute_b32 v130, v9, v30 offset:144
ds_bpermute_b32 v131, v9, v31 offset:144
ds_bpermute_b32 v132, v9, v30 offset:148
ds_bpermute_b32 v133, v9, v31 offset:148
ds_bpermute_b32 v134, v9, v30 offset:160
ds_bpermute_b32 v135, v9, v31 offset:160
ds_bpermute_b32 v136, v9, v30 offset:164
ds_bpermute_b32 v137, v9, v31 offset:164
ds_bpermute_b32 v138, v9, v30 offset:176
ds_bpermute_b32 v139, v9, v31 offset:176
ds_bpermute_b32 v140, v9, v30 offset:180
ds_bpermute_b32 v141, v9, v31 offset:180
s_waitcnt lgkmcnt(3)
ds_bpermute_b32 v142, v9, v30 offset:192
ds_bpermute_b32 v143, v9, v31 offset:192
ds_bpermute_b32 v144, v9, v30 offset:196
ds_bpermute_b32 v145, v9, v31 offset:196
ds_bpermute_b32 v146, v9, v30 offset:208
ds_bpermute_b32 v147, v9, v31 offset:208
ds_bpermute_b32 v148, v9, v30 offset:212
ds_bpermute_b32 v149, v9, v31 offset:212
ds_bpermute_b32 v150, v9, v30 offset:224
ds_bpermute_b32 v151, v9, v31 offset:224
ds_bpermute_b32 v152, v9, v30 offset:228
ds_bpermute_b32 v153, v9, v31 offset:228
s_waitcnt lgkmcnt(3)
ds_bpermute_b32 v154, v9, v30 offset:240
ds_bpermute_b32 v155, v9, v31 offset:240
ds_bpermute_b32 v156, v9, v30 offset:244
ds_bpermute_b32 v157, v9, v31 offset:244
v_lshrrev_b32 v8, 5, v1
v_bfe_u32 v9, v1, 2, 2
v_lshl_add_u32 v8, v8, 3, v9
v_lshlrev_b32 v8, 7, v8
v_bfe_u32 v12, v1, 4, 1
v_lshl_add_u32 v8, v12, 5, v8
v_and_b32 v12, 1, v1
v_lshl_add_u32 v8, v12, 4, v8
v_bfe_u32 v12, v1, 1, 1
v_lshl_add_u32 v8, v12, 3, v8
v_lshrrev_b32 v9, 1, v9
v_lshl_add_u32 v4, v9, 6, v8
v_xor_b32 v9, 1, v9
v_lshl_add_u32 v5, v9, 6, v8
s_add_u32 s62, s62, 98304
v_add_u32 v4, s62, v4
v_add_u32 v5, s62, v5
s_waitcnt lgkmcnt(0)
s_waitcnt vmcnt(0)
ds_read_b64_tr_b16 v[64:65], v4 offset:0
ds_read_b64_tr_b16 v[66:67], v4 offset:512
ds_read_b64_tr_b16 v[68:69], v5 offset:0
ds_read_b64_tr_b16 v[70:71], v5 offset:512
ds_read_b64_tr_b16 v[72:73], v4 offset:2048
ds_read_b64_tr_b16 v[74:75], v4 offset:2560
ds_read_b64_tr_b16 v[76:77], v5 offset:2048
ds_read_b64_tr_b16 v[78:79], v5 offset:2560
s_waitcnt lgkmcnt(4)
v_mfma_f32_32x32x16_bf16 v[32:47], v[64:67], v[94:97], 0
v_mfma_f32_32x32x16_bf16 v[48:63], v[68:71], v[94:97], 0
ds_read_b64_tr_b16 v[80:81], v4 offset:4096
ds_read_b64_tr_b16 v[82:83], v4 offset:4608
ds_read_b64_tr_b16 v[84:85], v5 offset:4096
ds_read_b64_tr_b16 v[86:87], v5 offset:4608
s_waitcnt lgkmcnt(4)
v_mfma_f32_32x32x16_bf16 v[32:47], v[72:75], v[98:101], v[32:47]
v_mfma_f32_32x32x16_bf16 v[48:63], v[76:79], v[98:101], v[48:63]
ds_read_b64_tr_b16 v[64:65], v4 offset:6144
ds_read_b64_tr_b16 v[66:67], v4 offset:6656
ds_read_b64_tr_b16 v[68:69], v5 offset:6144
ds_read_b64_tr_b16 v[70:71], v5 offset:6656
s_waitcnt lgkmcnt(4)
v_mfma_f32_32x32x16_bf16 v[32:47], v[80:83], v[102:105], v[32:47]
v_mfma_f32_32x32x16_bf16 v[48:63], v[84:87], v[102:105], v[48:63]
ds_read_b64_tr_b16 v[72:73], v4 offset:8192
ds_read_b64_tr_b16 v[74:75], v4 offset:8704
ds_read_b64_tr_b16 v[76:77], v5 offset:8192
ds_read_b64_tr_b16 v[78:79], v5 offset:8704
s_waitcnt lgkmcnt(4)
v_mfma_f32_32x32x16_bf16 v[32:47], v[64:67], v[106:109], v[32:47]
v_mfma_f32_32x32x16_bf16 v[48:63], v[68:71], v[106:109], v[48:63]
ds_read_b64_tr_b16 v[80:81], v4 offset:10240
ds_read_b64_tr_b16 v[82:83], v4 offset:10752
ds_read_b64_tr_b16 v[84:85], v5 offset:10240
ds_read_b64_tr_b16 v[86:87], v5 offset:10752
s_waitcnt lgkmcnt(4)
v_mfma_f32_32x32x16_bf16 v[32:47], v[72:75], v[110:113], v[32:47]
v_mfma_f32_32x32x16_bf16 v[48:63], v[76:79], v[110:113], v[48:63]
ds_read_b64_tr_b16 v[64:65], v4 offset:12288
ds_read_b64_tr_b16 v[66:67], v4 offset:12800
ds_read_b64_tr_b16 v[68:69], v5 offset:12288
ds_read_b64_tr_b16 v[70:71], v5 offset:12800
s_waitcnt lgkmcnt(4)
v_mfma_f32_32x32x16_bf16 v[32:47], v[80:83], v[114:117], v[32:47]
v_mfma_f32_32x32x16_bf16 v[48:63], v[84:87], v[114:117], v[48:63]
ds_read_b64_tr_b16 v[72:73], v4 offset:14336
ds_read_b64_tr_b16 v[74:75], v4 offset:14848
ds_read_b64_tr_b16 v[76:77], v5 offset:14336
ds_read_b64_tr_b16 v[78:79], v5 offset:14848
s_waitcnt lgkmcnt(4)
v_mfma_f32_32x32x16_bf16 v[32:47], v[64:67], v[118:121], v[32:47]
v_mfma_f32_32x32x16_bf16 v[48:63], v[68:71], v[118:121], v[48:63]
ds_read_b64_tr_b16 v[80:81], v4 offset:16384
ds_read_b64_tr_b16 v[82:83], v4 offset:16896
ds_read_b64_tr_b16 v[84:85], v5 offset:16384
ds_read_b64_tr_b16 v[86:87], v5 offset:16896
s_waitcnt lgkmcnt(4)
v_mfma_f32_32x32x16_bf16 v[32:47], v[72:75], v[122:125], v[32:47]
v_mfma_f32_32x32x16_bf16 v[48:63], v[76:79], v[122:125], v[48:63]
ds_read_b64_tr_b16 v[64:65], v4 offset:18432
ds_read_b64_tr_b16 v[66:67], v4 offset:18944
ds_read_b64_tr_b16 v[68:69], v5 offset:18432
ds_read_b64_tr_b16 v[70:71], v5 offset:18944
s_waitcnt lgkmcnt(4)
v_mfma_f32_32x32x16_bf16 v[32:47], v[80:83], v[126:129], v[32:47]
v_mfma_f32_32x32x16_bf16 v[48:63], v[84:87], v[126:129], v[48:63]
ds_read_b64_tr_b16 v[72:73], v4 offset:20480
ds_read_b64_tr_b16 v[74:75], v4 offset:20992
ds_read_b64_tr_b16 v[76:77], v5 offset:20480
ds_read_b64_tr_b16 v[78:79], v5 offset:20992
s_waitcnt lgkmcnt(4)
v_mfma_f32_32x32x16_bf16 v[32:47], v[64:67], v[130:133], v[32:47]
v_mfma_f32_32x32x16_bf16 v[48:63], v[68:71], v[130:133], v[48:63]
ds_read_b64_tr_b16 v[80:81], v4 offset:22528
ds_read_b64_tr_b16 v[82:83], v4 offset:23040
ds_read_b64_tr_b16 v[84:85], v5 offset:22528
ds_read_b64_tr_b16 v[86:87], v5 offset:23040
s_waitcnt lgkmcnt(4)
v_mfma_f32_32x32x16_bf16 v[32:47], v[72:75], v[134:137], v[32:47]
v_mfma_f32_32x32x16_bf16 v[48:63], v[76:79], v[134:137], v[48:63]
ds_read_b64_tr_b16 v[64:65], v4 offset:24576
ds_read_b64_tr_b16 v[66:67], v4 offset:25088
ds_read_b64_tr_b16 v[68:69], v5 offset:24576
ds_read_b64_tr_b16 v[70:71], v5 offset:25088
s_waitcnt lgkmcnt(4)
v_mfma_f32_32x32x16_bf16 v[32:47], v[80:83], v[138:141], v[32:47]
v_mfma_f32_32x32x16_bf16 v[48:63], v[84:87], v[138:141], v[48:63]
ds_read_b64_tr_b16 v[72:73], v4 offset:26624
ds_read_b64_tr_b16 v[74:75], v4 offset:27136
ds_read_b64_tr_b16 v[76:77], v5 offset:26624
ds_read_b64_tr_b16 v[78:79], v5 offset:27136
s_waitcnt lgkmcnt(4)
v_mfma_f32_32x32x16_bf16 v[32:47], v[64:67], v[142:145], v[32:47]
v_mfma_f32_32x32x16_bf16 v[48:63], v[68:71], v[142:145], v[48:63]
ds_read_b64_tr_b16 v[80:81], v4 offset:28672
ds_read_b64_tr_b16 v[82:83], v4 offset:29184
ds_read_b64_tr_b16 v[84:85], v5 offset:28672
ds_read_b64_tr_b16 v[86:87], v5 offset:29184
s_waitcnt lgkmcnt(4)
v_mfma_f32_32x32x16_bf16 v[32:47], v[72:75], v[146:149], v[32:47]
v_mfma_f32_32x32x16_bf16 v[48:63], v[76:79], v[146:149], v[48:63]
ds_read_b64_tr_b16 v[64:65], v4 offset:30720
ds_read_b64_tr_b16 v[66:67], v4 offset:31232
ds_read_b64_tr_b16 v[68:69], v5 offset:30720
ds_read_b64_tr_b16 v[70:71], v5 offset:31232
s_waitcnt lgkmcnt(4)
v_mfma_f32_32x32x16_bf16 v[32:47], v[80:83], v[150:153], v[32:47]
v_mfma_f32_32x32x16_bf16 v[48:63], v[84:87], v[150:153], v[48:63]
s_waitcnt lgkmcnt(0)
v_mfma_f32_32x32x16_bf16 v[32:47], v[64:67], v[154:157], v[32:47]
v_mfma_f32_32x32x16_bf16 v[48:63], v[68:71], v[154:157], v[48:63]
v_add_u32 v12, 131072, v11
v_mov_b32 v13, 139264
v_mov_b32 v14, s53
s_cmp_eq_u32 s52, 4
s_cbranch_scc1 Lg5_18
s_nop 5
ds_write_b128 v12, v[32:35] offset:0
ds_write_b128 v12, v[36:39] offset:1024
ds_write_b128 v12, v[40:43] offset:2048
ds_write_b128 v12, v[44:47] offset:3072
ds_write_b128 v12, v[48:51] offset:4096
ds_write_b128 v12, v[52:55] offset:5120
ds_write_b128 v12, v[56:59] offset:6144
ds_write_b128 v12, v[60:63] offset:7168
s_waitcnt lgkmcnt(0)
ds_write_b32 v13, v14
s_waitcnt lgkmcnt(0)
s_branch L_NOGEMV
Lg5_18:
s_mov_b32 s71, 0
Lgs_19:
ds_read_b32 v15, v13
s_add_u32 s71, s71, 1
s_cmp_gt_u32 s71, 4000000
s_cbranch_scc1 Lgso_20
s_waitcnt lgkmcnt(0)
v_cmp_ne_u32 vcc, s53, v15
s_nop 0
s_cbranch_vccnz Lgs_19
Lgso_20:
ds_read_b128 v[64:67], v12 offset:0
ds_read_b128 v[68:71], v12 offset:1024
ds_read_b128 v[72:75], v12 offset:2048
ds_read_b128 v[76:79], v12 offset:3072
ds_read_b128 v[80:83], v12 offset:4096
ds_read_b128 v[84:87], v12 offset:5120
ds_read_b128 v[88:91], v12 offset:6144
ds_read_b128 v[92:95], v12 offset:7168
s_lshl_b32 s65, s48, 12
s_lshl_b32 s66, s49, 8
s_add_u32 s65, s65, s66
s_add_u32 s68, s65, 40960
s_add_u32 s65, s65, 8192
s_lshl_b32 s69, s48, 10
s_add_u32 s69, s69, s66
s_add_u32 s69, s69, 69632
s_lshr_b32 s66, s49, 3
s_cmp_eq_u32 s66, 1
s_cselect_b32 s67, 1.0, 0
s_lshr_b32 s66, s48, 1
s_cmp_eq_u32 s66, 2
s_cselect_b32 s70, 1.0, 0
s_cmp_ge_u32 s49, 16
s_cselect_b32 s67, s70, s67
s_cselect_b32 s65, s69, s65
s_cselect_b32 s68, s69, s68
v_lshrrev_b32 v9, 5, v1
v_lshlrev_b32 v9, 5, v9
s_waitcnt lgkmcnt(0)
v_add_f32 v32, v32, v64
v_add_f32 v33, v33, v65
v_add_f32 v34, v34, v66
v_add_f32 v35, v35, v67
v_add_f32 v36, v36, v68
v_add_f32 v37, v37, v69
v_add_f32 v38, v38, v70
v_add_f32 v39, v39, v71
v_add_f32 v40, v40, v72
v_add_f32 v41, v41, v73
v_add_f32 v42, v42, v74
v_add_f32 v43, v43, v75
v_add_f32 v44, v44, v76
v_add_f32 v45, v45, v77
v_add_f32 v46, v46, v78
v_add_f32 v47, v47, v79
v_add_f32 v48, v48, v80
v_add_f32 v49, v49, v81
v_add_f32 v50, v50, v82
v_add_f32 v51, v51, v83
v_add_f32 v52, v52, v84
v_add_f32 v53, v53, v85
v_add_f32 v54, v54, v86
v_add_f32 v55, v55, v87
v_add_f32 v56, v56, v88
v_add_f32 v57, v57, v89
v_add_f32 v58, v58, v90
v_add_f32 v59, v59, v91
v_add_f32 v60, v60, v92
v_add_f32 v61, v61, v93
v_add_f32 v62, v62, v94
v_add_f32 v63, v63, v95
v_cvt_pk_bf16_f32 v64, v32, v33
v_cvt_pk_bf16_f32 v66, v34, v35
v_cvt_pk_bf16_f32 v68, v36, v37
v_cvt_pk_bf16_f32 v70, v38, v39
v_cvt_pk_bf16_f32 v72, v40, v41
v_cvt_pk_bf16_f32 v74, v42, v43
v_cvt_pk_bf16_f32 v76, v44, v45
v_cvt_pk_bf16_f32 v78, v46, v47
v_cvt_pk_bf16_f32 v80, v48, v49
v_cvt_pk_bf16_f32 v82, v50, v51
v_cvt_pk_bf16_f32 v84, v52, v53
v_cvt_pk_bf16_f32 v86, v54, v55
v_cvt_pk_bf16_f32 v88, v56, v57
v_cvt_pk_bf16_f32 v90, v58, v59
v_cvt_pk_bf16_f32 v92, v60, v61
v_cvt_pk_bf16_f32 v94, v62, v63
v_lshlrev_b32 v32, 16, v64
v_and_b32 v33, 0xffff0000, v64
v_lshlrev_b32 v34, 16, v66
v_and_b32 v35, 0xffff0000, v66
v_lshlrev_b32 v36, 16, v68
v_and_b32 v37, 0xffff0000, v68
v_lshlrev_b32 v38, 16, v70
v_and_b32 v39, 0xffff0000, v70
v_lshlrev_b32 v40, 16, v72
v_and_b32 v41, 0xffff0000, v72
v_lshlrev_b32 v42, 16, v74
v_and_b32 v43, 0xffff0000, v74
v_lshlrev_b32 v44, 16, v76
v_and_b32 v45, 0xffff0000, v76
v_lshlrev_b32 v46, 16, v78
v_and_b32 v47, 0xffff0000, v78
v_lshlrev_b32 v48, 16, v80
v_and_b32 v49, 0xffff0000, v80
v_lshlrev_b32 v50, 16, v82
v_and_b32 v51, 0xffff0000, v82
v_lshlrev_b32 v52, 16, v84
v_and_b32 v53, 0xffff0000, v84
v_lshlrev_b32 v54, 16, v86
v_and_b32 v55, 0xffff0000, v86
v_lshlrev_b32 v56, 16, v88
v_and_b32 v57, 0xffff0000, v88
v_lshlrev_b32 v58, 16, v90
v_and_b32 v59, 0xffff0000, v90
v_lshlrev_b32 v60, 16, v92
v_and_b32 v61, 0xffff0000, v92
v_lshlrev_b32 v62, 16, v94
v_and_b32 v63, 0xffff0000, v94
v_add_f32 v32, s67, v32
v_add_f32 v33, s67, v33
v_add_f32 v34, s67, v34
v_add_f32 v35, s67, v35
v_add_f32 v36, s67, v36
v_add_f32 v37, s67, v37
v_add_f32 v38, s67, v38
v_add_f32 v39, s67, v39
v_add_f32 v40, s67, v40
v_add_f32 v41, s67, v41
v_add_f32 v42, s67, v42
v_add_f32 v43, s67, v43
v_add_f32 v44, s67, v44
v_add_f32 v45, s67, v45
v_add_f32 v46, s67, v46
v_add_f32 v47, s67, v47
v_add_f32 v48, s67, v48
v_add_f32 v49, s67, v49
v_add_f32 v50, s67, v50
v_add_f32 v51, s67, v51
v_add_f32 v52, s67, v52
v_add_f32 v53, s67, v53
v_add_f32 v54, s67, v54
v_add_f32 v55, s67, v55
v_add_f32 v56, s67, v56
v_add_f32 v57, s67, v57
v_add_f32 v58, s67, v58
v_add_f32 v59, s67, v59
v_add_f32 v60, s67, v60
v_add_f32 v61, s67, v61
v_add_f32 v62, s67, v62
v_add_f32 v63, s67, v63
v_cvt_pk_bf16_f32 v64, v32, v33
v_mov_b32 v65, s53
v_cvt_pk_bf16_f32 v66, v34, v35
v_mov_b32 v67, s53
v_cvt_pk_bf16_f32 v68, v36, v37
v_mov_b32 v69, s53
v_cvt_pk_bf16_f32 v70, v38, v39
v_mov_b32 v71, s53
v_cvt_pk_bf16_f32 v72, v40, v41
v_mov_b32 v73, s53
v_cvt_pk_bf16_f32 v74, v42, v43
v_mov_b32 v75, s53
v_cvt_pk_bf16_f32 v76, v44, v45
v_mov_b32 v77, s53
v_cvt_pk_bf16_f32 v78, v46, v47
v_mov_b32 v79, s53
v_cvt_pk_bf16_f32 v80, v48, v49
v_mov_b32 v81, s53
v_cvt_pk_bf16_f32 v82, v50, v51
v_mov_b32 v83, s53
v_cvt_pk_bf16_f32 v84, v52, v53
v_mov_b32 v85, s53
v_cvt_pk_bf16_f32 v86, v54, v55
v_mov_b32 v87, s53
v_cvt_pk_bf16_f32 v88, v56, v57
v_mov_b32 v89, s53
v_cvt_pk_bf16_f32 v90, v58, v59
v_mov_b32 v91, s53
v_cvt_pk_bf16_f32 v92, v60, v61
v_mov_b32 v93, s53
v_cvt_pk_bf16_f32 v94, v62, v63
v_mov_b32 v95, s53
s_mov_b32 exec_lo, 1
s_mov_b32 exec_hi, 1
s_cmp_ge_u32 s49, 16
s_cbranch_scc1 Lnu_21
buffer_store_dwordx4 v[64:67], v9, s[44:47], s65 offen offset:0
buffer_store_dwordx4 v[68:71], v9, s[44:47], s65 offen offset:16
buffer_store_dwordx4 v[72:75], v9, s[44:47], s65 offen offset:64
buffer_store_dwordx4 v[76:79], v9, s[44:47], s65 offen offset:80
buffer_store_dwordx4 v[80:83], v9, s[44:47], s65 offen offset:128
buffer_store_dwordx4 v[84:87], v9, s[44:47], s65 offen offset:144
buffer_store_dwordx4 v[88:91], v9, s[44:47], s65 offen offset:192
buffer_store_dwordx4 v[92:95], v9, s[44:47], s65 offen offset:208
Lnu_21:
buffer_store_dwordx4 v[64:67], v9, s[44:47], s68 offen offset:0 sc1
buffer_store_dwordx4 v[68:71], v9, s[44:47], s68 offen offset:16 sc1
buffer_store_dwordx4 v[72:75], v9, s[44:47], s68 offen offset:64 sc1
buffer_store_dwordx4 v[76:79], v9, s[44:47], s68 offen offset:80 sc1
buffer_store_dwordx4 v[80:83], v9, s[44:47], s68 offen offset:128 sc1
buffer_store_dwordx4 v[84:87], v9, s[44:47], s68 offen offset:144 sc1
buffer_store_dwordx4 v[88:91], v9, s[44:47], s68 offen offset:192 sc1
buffer_store_dwordx4 v[92:95], v9, s[44:47], s68 offen offset:208 sc1
s_mov_b64 exec, -1
L_NOGEMV:
s_waitcnt lgkmcnt(0)
s_cmp_ge_u32 s49, 20
s_cbranch_scc0 Lj0_3
s_mul_i32 s53, s53, 1664525
s_add_u32 s53, s53, 1013904223
s_mul_i32 s60, s48, 12
s_add_u32 s60, s60, s49
s_sub_u32 s60, s60, 20
s_lshl_b32 s60, s60, 1
s_add_u32 s60, s60, s57
s_lshl_b32 s60, s60, 13
s_add_u32 s61, s60, 1572864
s_cmp_lt_u32 s60, 688128
s_cselect_b32 s61, s60, 0x7fff0000
s_sub_u32 s62, s60, 688128
s_cmp_lt_u32 s62, 688128
s_cselect_b32 s62, s62, 0x7fff0000
s_sub_u32 s63, s60, 1048576
s_min_u32 s63, s63, 0x7fff0000
buffer_load_dword v2, v10, s[20:23], s61 offen
buffer_load_dword v2, v10, s[24:27], s62 offen
buffer_load_dword v2, v10, s[16:19], s63 offen
s_branch Lj0_3
Lj0_3:
s_nop 4
s_barrier
s_lshl_b32 s60, s50, 8
s_lshl_b32 s61, s57, 6
s_add_u32 s60, s60, s61
s_add_u32 s60, s60, 139264
v_and_b32 v12, 15, v1
v_lshlrev_b32 v12, 2, v12
s_lshl_b32 s62, s48, 19
s_and_b32 s61, s50, 1
s_lshl_b32 s61, s61, 17
s_add_u32 s62, s62, s61
s_xor_b32 s61, s58, 1
s_lshl_b32 s61, s61, 18
s_add_u32 s62, s62, s61
s_lshl_b32 s61, s57, 15
s_add_u32 s62, s62, s61
s_add_u32 s62, s62, 18874368
v_lshrrev_b32 v8, 5, v1
v_bfe_u32 v9, v1, 2, 2
v_lshl_add_u32 v9, v8, 3, v9
v_lshlrev_b32 v4, 6, v9
v_bfe_u32 v9, v1, 4, 1
v_lshl_add_u32 v4, v9, 5, v4
v_and_b32 v9, 1, v1
v_lshl_add_u32 v4, v9, 4, v4
v_bfe_u32 v9, v1, 1, 1
v_lshl_add_u32 v4, v9, 3, v4
v_add_u32 v4, 0, v4
v_add_u32 v5, 32768, v4
v_add_u32 v6, 65536, v4
v_and_b32 v14, 31, v1
v_lshlrev_b32 v14, 3, v14
s_lshl_b32 s63, s48, 8
s_add_u32 s63, s63, 4096
s_mov_b32 s71, 0
P1_22:
buffer_load_dword v13, v12, s[44:47], s60 offen sc1
buffer_load_dwordx2 v[16:17], v14, s[44:47], s63 offen sc1
s_add_u32 s71, s71, 1
s_cmp_gt_u32 s71, 400000
s_cbranch_scc1 P1o_23
s_waitcnt vmcnt(0)
v_cmp_ne_u32 vcc, s53, v13
s_nop 0
s_cbranch_vccz P1o_23
s_sleep 2
s_branch P1_22
P1o_23:
s_waitcnt vmcnt(0)
v_xor_b32 v17, s53, v17
v_xor_b32 v16, s54, v16
v_or_b32 v16, v16, v17
v_cmp_ne_u32 vcc, 0, v16
s_nop 0
s_cmp_eq_u64 vcc, 0
s_cselect_b32 s55, 1, 0
s_cmp_ge_u32 s52, 4
s_cbranch_scc1 Lp1h_24
buffer_load_dwordx4 a[0:3], v11, s[44:47], s62 offen offset:0 sc1
buffer_load_dwordx4 a[4:7], v11, s[44:47], s62 offen offset:1024 sc1
buffer_load_dwordx4 a[8:11], v11, s[44:47], s62 offen offset:2048 sc1
buffer_load_dwordx4 a[12:15], v11, s[44:47], s62 offen offset:3072 sc1
s_add_u32 s62, s62, 4096
buffer_load_dwordx4 a[16:19], v11, s[44:47], s62 offen offset:0 sc1
buffer_load_dwordx4 a[20:23], v11, s[44:47], s62 offen offset:1024 sc1
buffer_load_dwordx4 a[24:27], v11, s[44:47], s62 offen offset:2048 sc1
buffer_load_dwordx4 a[28:31], v11, s[44:47], s62 offen offset:3072 sc1
s_add_u32 s62, s62, 4096
buffer_load_dwordx4 a[32:35], v11, s[44:47], s62 offen offset:0 sc1
buffer_load_dwordx4 a[36:39], v11, s[44:47], s62 offen offset:1024 sc1
ds_read_b64_tr_b16 v[68:69], v5 offset:0
ds_read_b64_tr_b16 v[70:71], v5 offset:256
ds_read_b64_tr_b16 v[72:73], v6 offset:0
ds_read_b64_tr_b16 v[74:75], v6 offset:256
ds_read_b64_tr_b16 v[64:65], v4 offset:0
ds_read_b64_tr_b16 v[66:67], v4 offset:256
ds_read_b64_tr_b16 v[80:81], v5 offset:1024
ds_read_b64_tr_b16 v[82:83], v5 offset:1280
ds_read_b64_tr_b16 v[84:85], v6 offset:1024
ds_read_b64_tr_b16 v[86:87], v6 offset:1280
ds_read_b64_tr_b16 v[76:77], v4 offset:1024
ds_read_b64_tr_b16 v[78:79], v4 offset:1280
s_waitcnt lgkmcnt(6)
s_waitcnt vmcnt(9)
v_mfma_f32_32x32x16_bf16 v[32:47], v[68:71], a[0:3], 0
ds_read_b64_tr_b16 v[92:93], v5 offset:2048
ds_read_b64_tr_b16 v[94:95], v5 offset:2304
v_mfma_f32_32x32x16_bf16 v[48:63], a[0:3], v[72:75], 0
ds_read_b64_tr_b16 v[96:97], v6 offset:2048
ds_read_b64_tr_b16 v[98:99], v6 offset:2304
v_mfma_f32_32x32x16_bf16 v[16:31], v[64:67], a[0:3], 0
ds_read_b64_tr_b16 v[88:89], v4 offset:2048
ds_read_b64_tr_b16 v[90:91], v4 offset:2304
buffer_load_dwordx4 a[40:43], v11, s[44:47], s62 offen offset:2048 sc1
s_waitcnt lgkmcnt(6)
s_waitcnt vmcnt(9)
v_mfma_f32_32x32x16_bf16 v[32:47], v[80:83], a[4:7], v[32:47]
ds_read_b64_tr_b16 v[68:69], v5 offset:3072
ds_read_b64_tr_b16 v[70:71], v5 offset:3328
v_mfma_f32_32x32x16_bf16 v[48:63], a[4:7], v[84:87], v[48:63]
ds_read_b64_tr_b16 v[72:73], v6 offset:3072
ds_read_b64_tr_b16 v[74:75], v6 offset:3328
v_mfma_f32_32x32x16_bf16 v[16:31], v[76:79], a[4:7], v[16:31]
ds_read_b64_tr_b16 v[64:65], v4 offset:3072
ds_read_b64_tr_b16 v[66:67], v4 offset:3328
buffer_load_dwordx4 a[44:47], v11, s[44:47], s62 offen offset:3072 sc1
s_waitcnt lgkmcnt(6)
s_waitcnt vmcnt(9)
v_mfma_f32_32x32x16_bf16 v[32:47], v[92:95], a[8:11], v[32:47]
ds_read_b64_tr_b16 v[80:81], v5 offset:4096
ds_read_b64_tr_b16 v[82:83], v5 offset:4352
v_mfma_f32_32x32x16_bf16 v[48:63], a[8:11], v[96:99], v[48:63]
ds_read_b64_tr_b16 v[84:85], v6 offset:4096
ds_read_b64_tr_b16 v[86:87], v6 offset:4352
v_mfma_f32_32x32x16_bf16 v[16:31], v[88:91], a[8:11], v[16:31]
ds_read_b64_tr_b16 v[76:77], v4 offset:4096
ds_read_b64_tr_b16 v[78:79], v4 offset:4352
s_add_u32 s62, s62, 4096
buffer_load_dwordx4 a[0:3], v11, s[44:47], s62 offen offset:0 sc1
s_waitcnt lgkmcnt(6)
s_waitcnt vmcnt(9)
v_mfma_f32_32x32x16_bf16 v[32:47], v[68:71], a[12:15], v[32:47]
ds_read_b64_tr_b16 v[92:93], v5 offset:5120
ds_read_b64_tr_b16 v[94:95], v5 offset:5376
v_mfma_f32_32x32x16_bf16 v[48:63], a[12:15], v[72:75], v[48:63]
ds_read_b64_tr_b16 v[96:97], v6 offset:5120
ds_read_b64_tr_b16 v[98:99], v6 offset:5376
v_mfma_f32_32x32x16_bf16 v[16:31], v[64:67], a[12:15], v[16:31]
ds_read_b64_tr_b16 v[88:89], v4 offset:5120
ds_read_b64_tr_b16 v[90:91], v4 offset:5376
buffer_load_dwordx4 a[4:7], v11, s[44:47], s62 offen offset:1024 sc1
s_waitcnt lgkmcnt(6)
s_waitcnt vmcnt(9)
v_mfma_f32_32x32x16_bf16 v[32:47], v[80:83], a[16:19], v[32:47]
ds_read_b64_tr_b16 v[68:69], v5 offset:6144
ds_read_b64_tr_b16 v[70:71], v5 offset:6400
v_mfma_f32_32x32x16_bf16 v[48:63], a[16:19], v[84:87], v[48:63]
ds_read_b64_tr_b16 v[72:73], v6 offset:6144
ds_read_b64_tr_b16 v[74:75], v6 offset:6400
v_mfma_f32_32x32x16_bf16 v[16:31], v[76:79], a[16:19], v[16:31]
ds_read_b64_tr_b16 v[64:65], v4 offset:6144
ds_read_b64_tr_b16 v[66:67], v4 offset:6400
buffer_load_dwordx4 a[8:11], v11, s[44:47], s62 offen offset:2048 sc1
s_waitcnt lgkmcnt(6)
s_waitcnt vmcnt(9)
v_mfma_f32_32x32x16_bf16 v[32:47], v[92:95], a[20:23], v[32:47]
ds_read_b64_tr_b16 v[80:81], v5 offset:7168
ds_read_b64_tr_b16 v[82:83], v5 offset:7424
v_mfma_f32_32x32x16_bf16 v[48:63], a[20:23], v[96:99], v[48:63]
ds_read_b64_tr_b16 v[84:85], v6 offset:7168
ds_read_b64_tr_b16 v[86:87], v6 offset:7424
v_mfma_f32_32x32x16_bf16 v[16:31], v[88:91], a[20:23], v[16:31]
ds_read_b64_tr_b16 v[76:77], v4 offset:7168
ds_read_b64_tr_b16 v[78:79], v4 offset:7424
buffer_load_dwordx4 a[12:15], v11, s[44:47], s62 offen offset:3072 sc1
s_waitcnt lgkmcnt(6)
s_waitcnt vmcnt(9)
v_mfma_f32_32x32x16_bf16 v[32:47], v[68:71], a[24:27], v[32:47]
ds_read_b64_tr_b16 v[92:93], v5 offset:8192
ds_read_b64_tr_b16 v[94:95], v5 offset:8448
v_mfma_f32_32x32x16_bf16 v[48:63], a[24:27], v[72:75], v[48:63]
ds_read_b64_tr_b16 v[96:97], v6 offset:8192
ds_read_b64_tr_b16 v[98:99], v6 offset:8448
v_mfma_f32_32x32x16_bf16 v[16:31], v[64:67], a[24:27], v[16:31]
ds_read_b64_tr_b16 v[88:89], v4 offset:8192
ds_read_b64_tr_b16 v[90:91], v4 offset:8448
s_add_u32 s62, s62, 4096
buffer_load_dwordx4 a[16:19], v11, s[44:47], s62 offen offset:0 sc1
s_waitcnt lgkmcnt(6)
s_waitcnt vmcnt(9)
v_mfma_f32_32x32x16_bf16 v[32:47], v[80:83], a[28:31], v[32:47]
ds_read_b64_tr_b16 v[68:69], v5 offset:9216
ds_read_b64_tr_b16 v[70:71], v5 offset:9472
v_mfma_f32_32x32x16_bf16 v[48:63], a[28:31], v[84:87], v[48:63]
ds_read_b64_tr_b16 v[72:73], v6 offset:9216
ds_read_b64_tr_b16 v[74:75], v6 offset:9472
v_mfma_f32_32x32x16_bf16 v[16:31], v[76:79], a[28:31], v[16:31]
ds_read_b64_tr_b16 v[64:65], v4 offset:9216
ds_read_b64_tr_b16 v[66:67], v4 offset:9472
buffer_load_dwordx4 a[20:23], v11, s[44:47], s62 offen offset:1024 sc1
s_waitcnt lgkmcnt(6)
s_waitcnt vmcnt(9)
v_mfma_f32_32x32x16_bf16 v[32:47], v[92:95], a[32:35], v[32:47]
ds_read_b64_tr_b16 v[80:81], v5 offset:10240
ds_read_b64_tr_b16 v[82:83], v5 offset:10496
v_mfma_f32_32x32x16_bf16 v[48:63], a[32:35], v[96:99], v[48:63]
ds_read_b64_tr_b16 v[84:85], v6 offset:10240
ds_read_b64_tr_b16 v[86:87], v6 offset:10496
v_mfma_f32_32x32x16_bf16 v[16:31], v[88:91], a[32:35], v[16:31]
ds_read_b64_tr_b16 v[76:77], v4 offset:10240
ds_read_b64_tr_b16 v[78:79], v4 offset:10496
buffer_load_dwordx4 a[24:27], v11, s[44:47], s62 offen offset:2048 sc1
s_waitcnt lgkmcnt(6)
s_waitcnt vmcnt(9)
v_mfma_f32_32x32x16_bf16 v[32:47], v[68:71], a[36:39], v[32:47]
ds_read_b64_tr_b16 v[92:93], v5 offset:11264
ds_read_b64_tr_b16 v[94:95], v5 offset:11520
v_mfma_f32_32x32x16_bf16 v[48:63], a[36:39], v[72:75], v[48:63]
ds_read_b64_tr_b16 v[96:97], v6 offset:11264
ds_read_b64_tr_b16 v[98:99], v6 offset:11520
v_mfma_f32_32x32x16_bf16 v[16:31], v[64:67], a[36:39], v[16:31]
ds_read_b64_tr_b16 v[88:89], v4 offset:11264
ds_read_b64_tr_b16 v[90:91], v4 offset:11520
buffer_load_dwordx4 a[28:31], v11, s[44:47], s62 offen offset:3072 sc1
s_waitcnt lgkmcnt(6)
s_waitcnt vmcnt(9)
v_mfma_f32_32x32x16_bf16 v[32:47], v[80:83], a[40:43], v[32:47]
ds_read_b64_tr_b16 v[68:69], v5 offset:12288
ds_read_b64_tr_b16 v[70:71], v5 offset:12544
v_mfma_f32_32x32x16_bf16 v[48:63], a[40:43], v[84:87], v[48:63]
ds_read_b64_tr_b16 v[72:73], v6 offset:12288
ds_read_b64_tr_b16 v[74:75], v6 offset:12544
v_mfma_f32_32x32x16_bf16 v[16:31], v[76:79], a[40:43], v[16:31]
ds_read_b64_tr_b16 v[64:65], v4 offset:12288
ds_read_b64_tr_b16 v[66:67], v4 offset:12544
s_add_u32 s62, s62, 4096
buffer_load_dwordx4 a[32:35], v11, s[44:47], s62 offen offset:0 sc1
s_waitcnt lgkmcnt(6)
s_waitcnt vmcnt(9)
v_mfma_f32_32x32x16_bf16 v[32:47], v[92:95], a[44:47], v[32:47]
ds_read_b64_tr_b16 v[80:81], v5 offset:13312
ds_read_b64_tr_b16 v[82:83], v5 offset:13568
v_mfma_f32_32x32x16_bf16 v[48:63], a[44:47], v[96:99], v[48:63]
ds_read_b64_tr_b16 v[84:85], v6 offset:13312
ds_read_b64_tr_b16 v[86:87], v6 offset:13568
v_mfma_f32_32x32x16_bf16 v[16:31], v[88:91], a[44:47], v[16:31]
ds_read_b64_tr_b16 v[76:77], v4 offset:13312
ds_read_b64_tr_b16 v[78:79], v4 offset:13568
buffer_load_dwordx4 a[36:39], v11, s[44:47], s62 offen offset:1024 sc1
s_waitcnt lgkmcnt(6)
s_waitcnt vmcnt(9)
v_mfma_f32_32x32x16_bf16 v[32:47], v[68:71], a[0:3], v[32:47]
ds_read_b64_tr_b16 v[92:93], v5 offset:14336
ds_read_b64_tr_b16 v[94:95], v5 offset:14592
v_mfma_f32_32x32x16_bf16 v[48:63], a[0:3], v[72:75], v[48:63]
ds_read_b64_tr_b16 v[96:97], v6 offset:14336
ds_read_b64_tr_b16 v[98:99], v6 offset:14592
v_mfma_f32_32x32x16_bf16 v[16:31], v[64:67], a[0:3], v[16:31]
ds_read_b64_tr_b16 v[88:89], v4 offset:14336
ds_read_b64_tr_b16 v[90:91], v4 offset:14592
buffer_load_dwordx4 a[40:43], v11, s[44:47], s62 offen offset:2048 sc1
s_waitcnt lgkmcnt(6)
s_waitcnt vmcnt(9)
v_mfma_f32_32x32x16_bf16 v[32:47], v[80:83], a[4:7], v[32:47]
ds_read_b64_tr_b16 v[68:69], v5 offset:15360
ds_read_b64_tr_b16 v[70:71], v5 offset:15616
v_mfma_f32_32x32x16_bf16 v[48:63], a[4:7], v[84:87], v[48:63]
ds_read_b64_tr_b16 v[72:73], v6 offset:15360
ds_read_b64_tr_b16 v[74:75], v6 offset:15616
v_mfma_f32_32x32x16_bf16 v[16:31], v[76:79], a[4:7], v[16:31]
ds_read_b64_tr_b16 v[64:65], v4 offset:15360
ds_read_b64_tr_b16 v[66:67], v4 offset:15616
buffer_load_dwordx4 a[44:47], v11, s[44:47], s62 offen offset:3072 sc1
s_waitcnt lgkmcnt(6)
s_waitcnt vmcnt(9)
v_mfma_f32_32x32x16_bf16 v[32:47], v[92:95], a[8:11], v[32:47]
ds_read_b64_tr_b16 v[80:81], v5 offset:16384
ds_read_b64_tr_b16 v[82:83], v5 offset:16640
v_mfma_f32_32x32x16_bf16 v[48:63], a[8:11], v[96:99], v[48:63]
ds_read_b64_tr_b16 v[84:85], v6 offset:16384
ds_read_b64_tr_b16 v[86:87], v6 offset:16640
v_mfma_f32_32x32x16_bf16 v[16:31], v[88:91], a[8:11], v[16:31]
ds_read_b64_tr_b16 v[76:77], v4 offset:16384
ds_read_b64_tr_b16 v[78:79], v4 offset:16640
s_add_u32 s62, s62, 4096
buffer_load_dwordx4 a[0:3], v11, s[44:47], s62 offen offset:0 sc1
s_waitcnt lgkmcnt(6)
s_waitcnt vmcnt(9)
v_mfma_f32_32x32x16_bf16 v[32:47], v[68:71], a[12:15], v[32:47]
ds_read_b64_tr_b16 v[92:93], v5 offset:17408
ds_read_b64_tr_b16 v[94:95], v5 offset:17664
v_mfma_f32_32x32x16_bf16 v[48:63], a[12:15], v[72:75], v[48:63]
ds_read_b64_tr_b16 v[96:97], v6 offset:17408
ds_read_b64_tr_b16 v[98:99], v6 offset:17664
v_mfma_f32_32x32x16_bf16 v[16:31], v[64:67], a[12:15], v[16:31]
ds_read_b64_tr_b16 v[88:89], v4 offset:17408
ds_read_b64_tr_b16 v[90:91], v4 offset:17664
buffer_load_dwordx4 a[4:7], v11, s[44:47], s62 offen offset:1024 sc1
s_waitcnt lgkmcnt(6)
s_waitcnt vmcnt(9)
v_mfma_f32_32x32x16_bf16 v[32:47], v[80:83], a[16:19], v[32:47]
ds_read_b64_tr_b16 v[68:69], v5 offset:18432
ds_read_b64_tr_b16 v[70:71], v5 offset:18688
v_mfma_f32_32x32x16_bf16 v[48:63], a[16:19], v[84:87], v[48:63]
ds_read_b64_tr_b16 v[72:73], v6 offset:18432
ds_read_b64_tr_b16 v[74:75], v6 offset:18688
v_mfma_f32_32x32x16_bf16 v[16:31], v[76:79], a[16:19], v[16:31]
ds_read_b64_tr_b16 v[64:65], v4 offset:18432
ds_read_b64_tr_b16 v[66:67], v4 offset:18688
buffer_load_dwordx4 a[8:11], v11, s[44:47], s62 offen offset:2048 sc1
s_waitcnt lgkmcnt(6)
s_waitcnt vmcnt(9)
v_mfma_f32_32x32x16_bf16 v[32:47], v[92:95], a[20:23], v[32:47]
ds_read_b64_tr_b16 v[80:81], v5 offset:19456
ds_read_b64_tr_b16 v[82:83], v5 offset:19712
v_mfma_f32_32x32x16_bf16 v[48:63], a[20:23], v[96:99], v[48:63]
ds_read_b64_tr_b16 v[84:85], v6 offset:19456
ds_read_b64_tr_b16 v[86:87], v6 offset:19712
v_mfma_f32_32x32x16_bf16 v[16:31], v[88:91], a[20:23], v[16:31]
ds_read_b64_tr_b16 v[76:77], v4 offset:19456
ds_read_b64_tr_b16 v[78:79], v4 offset:19712
buffer_load_dwordx4 a[12:15], v11, s[44:47], s62 offen offset:3072 sc1
s_waitcnt lgkmcnt(6)
s_waitcnt vmcnt(9)
v_mfma_f32_32x32x16_bf16 v[32:47], v[68:71], a[24:27], v[32:47]
ds_read_b64_tr_b16 v[92:93], v5 offset:20480
ds_read_b64_tr_b16 v[94:95], v5 offset:20736
v_mfma_f32_32x32x16_bf16 v[48:63], a[24:27], v[72:75], v[48:63]
ds_read_b64_tr_b16 v[96:97], v6 offset:20480
ds_read_b64_tr_b16 v[98:99], v6 offset:20736
v_mfma_f32_32x32x16_bf16 v[16:31], v[64:67], a[24:27], v[16:31]
ds_read_b64_tr_b16 v[88:89], v4 offset:20480
ds_read_b64_tr_b16 v[90:91], v4 offset:20736
s_add_u32 s62, s62, 4096
buffer_load_dwordx4 a[16:19], v11, s[44:47], s62 offen offset:0 sc1
s_waitcnt lgkmcnt(6)
s_waitcnt vmcnt(9)
v_mfma_f32_32x32x16_bf16 v[32:47], v[80:83], a[28:31], v[32:47]
ds_read_b64_tr_b16 v[68:69], v5 offset:21504
ds_read_b64_tr_b16 v[70:71], v5 offset:21760
v_mfma_f32_32x32x16_bf16 v[48:63], a[28:31], v[84:87], v[48:63]
ds_read_b64_tr_b16 v[72:73], v6 offset:21504
ds_read_b64_tr_b16 v[74:75], v6 offset:21760
v_mfma_f32_32x32x16_bf16 v[16:31], v[76:79], a[28:31], v[16:31]
ds_read_b64_tr_b16 v[64:65], v4 offset:21504
ds_read_b64_tr_b16 v[66:67], v4 offset:21760
buffer_load_dwordx4 a[20:23], v11, s[44:47], s62 offen offset:1024 sc1
s_waitcnt lgkmcnt(6)
s_waitcnt vmcnt(9)
v_mfma_f32_32x32x16_bf16 v[32:47], v[92:95], a[32:35], v[32:47]
ds_read_b64_tr_b16 v[80:81], v5 offset:22528
ds_read_b64_tr_b16 v[82:83], v5 offset:22784
v_mfma_f32_32x32x16_bf16 v[48:63], a[32:35], v[96:99], v[48:63]
ds_read_b64_tr_b16 v[84:85], v6 offset:22528
ds_read_b64_tr_b16 v[86:87], v6 offset:22784
v_mfma_f32_32x32x16_bf16 v[16:31], v[88:91], a[32:35], v[16:31]
ds_read_b64_tr_b16 v[76:77], v4 offset:22528
ds_read_b64_tr_b16 v[78:79], v4 offset:22784
buffer_load_dwordx4 a[24:27], v11, s[44:47], s62 offen offset:2048 sc1
s_waitcnt lgkmcnt(6)
s_waitcnt vmcnt(9)
v_mfma_f32_32x32x16_bf16 v[32:47], v[68:71], a[36:39], v[32:47]
ds_read_b64_tr_b16 v[92:93], v5 offset:23552
ds_read_b64_tr_b16 v[94:95], v5 offset:23808
v_mfma_f32_32x32x16_bf16 v[48:63], a[36:39], v[72:75], v[48:63]
ds_read_b64_tr_b16 v[96:97], v6 offset:23552
ds_read_b64_tr_b16 v[98:99], v6 offset:23808
v_mfma_f32_32x32x16_bf16 v[16:31], v[64:67], a[36:39], v[16:31]
ds_read_b64_tr_b16 v[88:89], v4 offset:23552
ds_read_b64_tr_b16 v[90:91], v4 offset:23808
buffer_load_dwordx4 a[28:31], v11, s[44:47], s62 offen offset:3072 sc1
s_waitcnt lgkmcnt(6)
s_waitcnt vmcnt(9)
v_mfma_f32_32x32x16_bf16 v[32:47], v[80:83], a[40:43], v[32:47]
ds_read_b64_tr_b16 v[68:69], v5 offset:24576
ds_read_b64_tr_b16 v[70:71], v5 offset:24832
v_mfma_f32_32x32x16_bf16 v[48:63], a[40:43], v[84:87], v[48:63]
ds_read_b64_tr_b16 v[72:73], v6 offset:24576
ds_read_b64_tr_b16 v[74:75], v6 offset:24832
v_mfma_f32_32x32x16_bf16 v[16:31], v[76:79], a[40:43], v[16:31]
ds_read_b64_tr_b16 v[64:65], v4 offset:24576
ds_read_b64_tr_b16 v[66:67], v4 offset:24832
s_waitcnt lgkmcnt(6)
s_waitcnt vmcnt(8)
v_mfma_f32_32x32x16_bf16 v[32:47], v[92:95], a[44:47], v[32:47]
ds_read_b64_tr_b16 v[80:81], v5 offset:25600
ds_read_b64_tr_b16 v[82:83], v5 offset:25856
v_mfma_f32_32x32x16_bf16 v[48:63], a[44:47], v[96:99], v[48:63]
ds_read_b64_tr_b16 v[84:85], v6 offset:25600
ds_read_b64_tr_b16 v[86:87], v6 offset:25856
v_mfma_f32_32x32x16_bf16 v[16:31], v[88:91], a[44:47], v[16:31]
ds_read_b64_tr_b16 v[76:77], v4 offset:25600
ds_read_b64_tr_b16 v[78:79], v4 offset:25856
s_waitcnt lgkmcnt(6)
s_waitcnt vmcnt(7)
v_mfma_f32_32x32x16_bf16 v[32:47], v[68:71], a[0:3], v[32:47]
ds_read_b64_tr_b16 v[92:93], v5 offset:26624
ds_read_b64_tr_b16 v[94:95], v5 offset:26880
v_mfma_f32_32x32x16_bf16 v[48:63], a[0:3], v[72:75], v[48:63]
ds_read_b64_tr_b16 v[96:97], v6 offset:26624
ds_read_b64_tr_b16 v[98:99], v6 offset:26880
v_mfma_f32_32x32x16_bf16 v[16:31], v[64:67], a[0:3], v[16:31]
ds_read_b64_tr_b16 v[88:89], v4 offset:26624
ds_read_b64_tr_b16 v[90:91], v4 offset:26880
s_waitcnt lgkmcnt(6)
s_waitcnt vmcnt(6)
v_mfma_f32_32x32x16_bf16 v[32:47], v[80:83], a[4:7], v[32:47]
ds_read_b64_tr_b16 v[68:69], v5 offset:27648
ds_read_b64_tr_b16 v[70:71], v5 offset:27904
v_mfma_f32_32x32x16_bf16 v[48:63], a[4:7], v[84:87], v[48:63]
ds_read_b64_tr_b16 v[72:73], v6 offset:27648
ds_read_b64_tr_b16 v[74:75], v6 offset:27904
v_mfma_f32_32x32x16_bf16 v[16:31], v[76:79], a[4:7], v[16:31]
ds_read_b64_tr_b16 v[64:65], v4 offset:27648
ds_read_b64_tr_b16 v[66:67], v4 offset:27904
s_waitcnt lgkmcnt(6)
s_waitcnt vmcnt(5)
v_mfma_f32_32x32x16_bf16 v[32:47], v[92:95], a[8:11], v[32:47]
ds_read_b64_tr_b16 v[80:81], v5 offset:28672
ds_read_b64_tr_b16 v[82:83], v5 offset:28928
v_mfma_f32_32x32x16_bf16 v[48:63], a[8:11], v[96:99], v[48:63]
ds_read_b64_tr_b16 v[84:85], v6 offset:28672
ds_read_b64_tr_b16 v[86:87], v6 offset:28928
v_mfma_f32_32x32x16_bf16 v[16:31], v[88:91], a[8:11], v[16:31]
ds_read_b64_tr_b16 v[76:77], v4 offset:28672
ds_read_b64_tr_b16 v[78:79], v4 offset:28928
s_waitcnt lgkmcnt(6)
s_waitcnt vmcnt(4)
v_mfma_f32_32x32x16_bf16 v[32:47], v[68:71], a[12:15], v[32:47]
ds_read_b64_tr_b16 v[92:93], v5 offset:29696
ds_read_b64_tr_b16 v[94:95], v5 offset:29952
v_mfma_f32_32x32x16_bf16 v[48:63], a[12:15], v[72:75], v[48:63]
ds_read_b64_tr_b16 v[96:97], v6 offset:29696
ds_read_b64_tr_b16 v[98:99], v6 offset:29952
v_mfma_f32_32x32x16_bf16 v[16:31], v[64:67], a[12:15], v[16:31]
ds_read_b64_tr_b16 v[88:89], v4 offset:29696
ds_read_b64_tr_b16 v[90:91], v4 offset:29952
s_waitcnt lgkmcnt(6)
s_waitcnt vmcnt(3)
v_mfma_f32_32x32x16_bf16 v[32:47], v[80:83], a[16:19], v[32:47]
ds_read_b64_tr_b16 v[68:69], v5 offset:30720
ds_read_b64_tr_b16 v[70:71], v5 offset:30976
v_mfma_f32_32x32x16_bf16 v[48:63], a[16:19], v[84:87], v[48:63]
ds_read_b64_tr_b16 v[72:73], v6 offset:30720
ds_read_b64_tr_b16 v[74:75], v6 offset:30976
v_mfma_f32_32x32x16_bf16 v[16:31], v[76:79], a[16:19], v[16:31]
ds_read_b64_tr_b16 v[64:65], v4 offset:30720
ds_read_b64_tr_b16 v[66:67], v4 offset:30976
s_waitcnt lgkmcnt(6)
s_waitcnt vmcnt(2)
v_mfma_f32_32x32x16_bf16 v[32:47], v[92:95], a[20:23], v[32:47]
ds_read_b64_tr_b16 v[80:81], v5 offset:31744
ds_read_b64_tr_b16 v[82:83], v5 offset:32000
v_mfma_f32_32x32x16_bf16 v[48:63], a[20:23], v[96:99], v[48:63]
ds_read_b64_tr_b16 v[84:85], v6 offset:31744
ds_read_b64_tr_b16 v[86:87], v6 offset:32000
v_mfma_f32_32x32x16_bf16 v[16:31], v[88:91], a[20:23], v[16:31]
ds_read_b64_tr_b16 v[76:77], v4 offset:31744
ds_read_b64_tr_b16 v[78:79], v4 offset:32000
s_waitcnt lgkmcnt(6)
s_waitcnt vmcnt(1)
v_mfma_f32_32x32x16_bf16 v[32:47], v[68:71], a[24:27], v[32:47]
v_mfma_f32_32x32x16_bf16 v[48:63], a[24:27], v[72:75], v[48:63]
v_mfma_f32_32x32x16_bf16 v[16:31], v[64:67], a[24:27], v[16:31]
s_waitcnt lgkmcnt(0)
s_waitcnt vmcnt(0)
v_mfma_f32_32x32x16_bf16 v[32:47], v[80:83], a[28:31], v[32:47]
v_mfma_f32_32x32x16_bf16 v[48:63], a[28:31], v[84:87], v[48:63]
v_mfma_f32_32x32x16_bf16 v[16:31], v[76:79], a[28:31], v[16:31]
s_branch Lp1j_25
Lp1h_24:
v_lshrrev_b32 v126, 3, v1
v_mul_u32_u24 v126, 1024, v126
v_and_b32 v2, 7, v1
v_bfe_u32 v127, v1, 4, 1
v_lshlrev_b32 v127, 2, v127
v_xor_b32 v2, v2, v127
v_lshl_add_u32 v126, v2, 4, v126
s_and_b32 s65, s51, 7
s_lshl_b32 s65, s65, 7
s_lshl_b32 s66, s57, 13
s_add_u32 s65, s65, s66
s_lshl_b32 s66, s57, 10
buffer_load_dwordx4 a[0:3], v11, s[44:47], s62 offen offset:0 sc1
buffer_load_dwordx4 a[4:7], v11, s[44:47], s62 offen offset:1024 sc1
buffer_load_dwordx4 a[8:11], v11, s[44:47], s62 offen offset:2048 sc1
buffer_load_dwordx4 a[12:15], v11, s[44:47], s62 offen offset:3072 sc1
s_add_u32 s62, s62, 4096
buffer_load_dwordx4 a[16:19], v11, s[44:47], s62 offen offset:0 sc1
buffer_load_dwordx4 a[20:23], v11, s[44:47], s62 offen offset:1024 sc1
buffer_load_dwordx4 a[24:27], v11, s[44:47], s62 offen offset:2048 sc1
buffer_load_dwordx4 a[28:31], v11, s[44:47], s62 offen offset:3072 sc1
s_add_u32 s62, s62, 4096
buffer_load_dwordx4 a[32:35], v11, s[44:47], s62 offen offset:0 sc1
buffer_load_dwordx4 a[36:39], v11, s[44:47], s62 offen offset:1024 sc1
ds_read_b64_tr_b16 v[68:69], v5 offset:0
ds_read_b64_tr_b16 v[70:71], v5 offset:256
ds_read_b64_tr_b16 v[72:73], v6 offset:0
ds_read_b64_tr_b16 v[74:75], v6 offset:256
ds_read_b64_tr_b16 v[80:81], v5 offset:1024
ds_read_b64_tr_b16 v[82:83], v5 offset:1280
ds_read_b64_tr_b16 v[84:85], v6 offset:1024
ds_read_b64_tr_b16 v[86:87], v6 offset:1280
s_waitcnt lgkmcnt(4)
s_waitcnt vmcnt(9)
v_mfma_f32_32x32x16_bf16 v[32:47], v[68:71], a[0:3], 0
ds_read_b64_tr_b16 v[92:93], v5 offset:2048
ds_read_b64_tr_b16 v[94:95], v5 offset:2304
v_mfma_f32_32x32x16_bf16 v[48:63], a[0:3], v[72:75], 0
ds_read_b64_tr_b16 v[96:97], v6 offset:2048
ds_read_b64_tr_b16 v[98:99], v6 offset:2304
buffer_load_dwordx4 a[40:43], v11, s[44:47], s62 offen offset:2048 sc1
s_add_u32 m0, s66, 98304
s_add_u32 s67, s65, 0
buffer_load_dwordx4 v126, s[16:19], s67 offen lds
s_waitcnt lgkmcnt(4)
s_waitcnt vmcnt(10)
v_mfma_f32_32x32x16_bf16 v[32:47], v[80:83], a[4:7], v[32:47]
ds_read_b64_tr_b16 v[68:69], v5 offset:3072
ds_read_b64_tr_b16 v[70:71], v5 offset:3328
v_mfma_f32_32x32x16_bf16 v[48:63], a[4:7], v[84:87], v[48:63]
ds_read_b64_tr_b16 v[72:73], v6 offset:3072
ds_read_b64_tr_b16 v[74:75], v6 offset:3328
buffer_load_dwordx4 a[44:47], v11, s[44:47], s62 offen offset:3072 sc1
s_add_u32 m0, s66, 102400
s_add_u32 s67, s65, 32768
buffer_load_dwordx4 v126, s[16:19], s67 offen lds
s_waitcnt lgkmcnt(4)
s_waitcnt vmcnt(11)
v_mfma_f32_32x32x16_bf16 v[32:47], v[92:95], a[8:11], v[32:47]
ds_read_b64_tr_b16 v[80:81], v5 offset:4096
ds_read_b64_tr_b16 v[82:83], v5 offset:4352
v_mfma_f32_32x32x16_bf16 v[48:63], a[8:11], v[96:99], v[48:63]
ds_read_b64_tr_b16 v[84:85], v6 offset:4096
ds_read_b64_tr_b16 v[86:87], v6 offset:4352
s_add_u32 s62, s62, 4096
buffer_load_dwordx4 a[0:3], v11, s[44:47], s62 offen offset:0 sc1
s_add_u32 m0, s66, 106496
s_add_u32 s67, s65, 65536
buffer_load_dwordx4 v126, s[16:19], s67 offen lds
s_waitcnt lgkmcnt(4)
s_waitcnt vmcnt(12)
v_mfma_f32_32x32x16_bf16 v[32:47], v[68:71], a[12:15], v[32:47]
ds_read_b64_tr_b16 v[92:93], v5 offset:5120
ds_read_b64_tr_b16 v[94:95], v5 offset:5376
v_mfma_f32_32x32x16_bf16 v[48:63], a[12:15], v[72:75], v[48:63]
ds_read_b64_tr_b16 v[96:97], v6 offset:5120
ds_read_b64_tr_b16 v[98:99], v6 offset:5376
buffer_load_dwordx4 a[4:7], v11, s[44:47], s62 offen offset:1024 sc1
s_add_u32 m0, s66, 110592
s_add_u32 s67, s65, 98304
buffer_load_dwordx4 v126, s[16:19], s67 offen lds
s_waitcnt lgkmcnt(4)
s_waitcnt vmcnt(13)
v_mfma_f32_32x32x16_bf16 v[32:47], v[80:83], a[16:19], v[32:47]
ds_read_b64_tr_b16 v[68:69], v5 offset:6144
ds_read_b64_tr_b16 v[70:71], v5 offset:6400
v_mfma_f32_32x32x16_bf16 v[48:63], a[16:19], v[84:87], v[48:63]
ds_read_b64_tr_b16 v[72:73], v6 offset:6144
ds_read_b64_tr_b16 v[74:75], v6 offset:6400
buffer_load_dwordx4 a[8:11], v11, s[44:47], s62 offen offset:2048 sc1
s_add_u32 m0, s66, 114688
s_add_u32 s67, s65, 131072
buffer_load_dwordx4 v126, s[16:19], s67 offen lds
s_waitcnt lgkmcnt(4)
s_waitcnt vmcnt(14)
v_mfma_f32_32x32x16_bf16 v[32:47], v[92:95], a[20:23], v[32:47]
ds_read_b64_tr_b16 v[80:81], v5 offset:7168
ds_read_b64_tr_b16 v[82:83], v5 offset:7424
v_mfma_f32_32x32x16_bf16 v[48:63], a[20:23], v[96:99], v[48:63]
ds_read_b64_tr_b16 v[84:85], v6 offset:7168
ds_read_b64_tr_b16 v[86:87], v6 offset:7424
buffer_load_dwordx4 a[12:15], v11, s[44:47], s62 offen offset:3072 sc1
s_add_u32 m0, s66, 118784
s_add_u32 s67, s65, 163840
buffer_load_dwordx4 v126, s[16:19], s67 offen lds
s_waitcnt lgkmcnt(4)
s_waitcnt vmcnt(15)
v_mfma_f32_32x32x16_bf16 v[32:47], v[68:71], a[24:27], v[32:47]
ds_read_b64_tr_b16 v[92:93], v5 offset:8192
ds_read_b64_tr_b16 v[94:95], v5 offset:8448
v_mfma_f32_32x32x16_bf16 v[48:63], a[24:27], v[72:75], v[48:63]
ds_read_b64_tr_b16 v[96:97], v6 offset:8192
ds_read_b64_tr_b16 v[98:99], v6 offset:8448
s_add_u32 s62, s62, 4096
buffer_load_dwordx4 a[16:19], v11, s[44:47], s62 offen offset:0 sc1
s_add_u32 m0, s66, 122880
s_add_u32 s67, s65, 196608
buffer_load_dwordx4 v126, s[16:19], s67 offen lds
s_waitcnt lgkmcnt(4)
s_waitcnt vmcnt(16)
v_mfma_f32_32x32x16_bf16 v[32:47], v[80:83], a[28:31], v[32:47]
ds_read_b64_tr_b16 v[68:69], v5 offset:9216
ds_read_b64_tr_b16 v[70:71], v5 offset:9472
v_mfma_f32_32x32x16_bf16 v[48:63], a[28:31], v[84:87], v[48:63]
ds_read_b64_tr_b16 v[72:73], v6 offset:9216
ds_read_b64_tr_b16 v[74:75], v6 offset:9472
buffer_load_dwordx4 a[20:23], v11, s[44:47], s62 offen offset:1024 sc1
s_add_u32 m0, s66, 126976
s_add_u32 s67, s65, 229376
buffer_load_dwordx4 v126, s[16:19], s67 offen lds
s_waitcnt lgkmcnt(4)
s_waitcnt vmcnt(17)
v_mfma_f32_32x32x16_bf16 v[32:47], v[92:95], a[32:35], v[32:47]
ds_read_b64_tr_b16 v[80:81], v5 offset:10240
ds_read_b64_tr_b16 v[82:83], v5 offset:10496
v_mfma_f32_32x32x16_bf16 v[48:63], a[32:35], v[96:99], v[48:63]
ds_read_b64_tr_b16 v[84:85], v6 offset:10240
ds_read_b64_tr_b16 v[86:87], v6 offset:10496
buffer_load_dwordx4 a[24:27], v11, s[44:47], s62 offen offset:2048 sc1
s_add_u32 m0, s66, 131072
s_add_u32 s67, s65, 262144
buffer_load_dwordx4 v126, s[16:19], s67 offen lds
s_waitcnt lgkmcnt(4)
s_waitcnt vmcnt(18)
v_mfma_f32_32x32x16_bf16 v[32:47], v[68:71], a[36:39], v[32:47]
ds_read_b64_tr_b16 v[92:93], v5 offset:11264
ds_read_b64_tr_b16 v[94:95], v5 offset:11520
v_mfma_f32_32x32x16_bf16 v[48:63], a[36:39], v[72:75], v[48:63]
ds_read_b64_tr_b16 v[96:97], v6 offset:11264
ds_read_b64_tr_b16 v[98:99], v6 offset:11520
buffer_load_dwordx4 a[28:31], v11, s[44:47], s62 offen offset:3072 sc1
s_add_u32 m0, s66, 135168
s_add_u32 s67, s65, 294912
buffer_load_dwordx4 v126, s[16:19], s67 offen lds
s_waitcnt lgkmcnt(4)
s_waitcnt vmcnt(19)
v_mfma_f32_32x32x16_bf16 v[32:47], v[80:83], a[40:43], v[32:47]
ds_read_b64_tr_b16 v[68:69], v5 offset:12288
ds_read_b64_tr_b16 v[70:71], v5 offset:12544
v_mfma_f32_32x32x16_bf16 v[48:63], a[40:43], v[84:87], v[48:63]
ds_read_b64_tr_b16 v[72:73], v6 offset:12288
ds_read_b64_tr_b16 v[74:75], v6 offset:12544
s_add_u32 s62, s62, 4096
buffer_load_dwordx4 a[32:35], v11, s[44:47], s62 offen offset:0 sc1
s_add_u32 m0, s66, 139264
s_add_u32 s67, s65, 327680
buffer_load_dwordx4 v126, s[16:19], s67 offen lds
s_waitcnt lgkmcnt(4)
s_waitcnt vmcnt(19)
v_mfma_f32_32x32x16_bf16 v[32:47], v[92:95], a[44:47], v[32:47]
ds_read_b64_tr_b16 v[80:81], v5 offset:13312
ds_read_b64_tr_b16 v[82:83], v5 offset:13568
v_mfma_f32_32x32x16_bf16 v[48:63], a[44:47], v[96:99], v[48:63]
ds_read_b64_tr_b16 v[84:85], v6 offset:13312
ds_read_b64_tr_b16 v[86:87], v6 offset:13568
buffer_load_dwordx4 a[36:39], v11, s[44:47], s62 offen offset:1024 sc1
s_add_u32 m0, s66, 143360
s_add_u32 s67, s65, 360448
buffer_load_dwordx4 v126, s[16:19], s67 offen lds
s_waitcnt lgkmcnt(4)
s_waitcnt vmcnt(19)
v_mfma_f32_32x32x16_bf16 v[32:47], v[68:71], a[0:3], v[32:47]
ds_read_b64_tr_b16 v[92:93], v5 offset:14336
ds_read_b64_tr_b16 v[94:95], v5 offset:14592
v_mfma_f32_32x32x16_bf16 v[48:63], a[0:3], v[72:75], v[48:63]
ds_read_b64_tr_b16 v[96:97], v6 offset:14336
ds_read_b64_tr_b16 v[98:99], v6 offset:14592
buffer_load_dwordx4 a[40:43], v11, s[44:47], s62 offen offset:2048 sc1
s_add_u32 m0, s66, 147456
s_add_u32 s67, s65, 393216
buffer_load_dwordx4 v126, s[16:19], s67 offen lds
s_waitcnt lgkmcnt(4)
s_waitcnt vmcnt(19)
v_mfma_f32_32x32x16_bf16 v[32:47], v[80:83], a[4:7], v[32:47]
ds_read_b64_tr_b16 v[68:69], v5 offset:15360
ds_read_b64_tr_b16 v[70:71], v5 offset:15616
v_mfma_f32_32x32x16_bf16 v[48:63], a[4:7], v[84:87], v[48:63]
ds_read_b64_tr_b16 v[72:73], v6 offset:15360
ds_read_b64_tr_b16 v[74:75], v6 offset:15616
buffer_load_dwordx4 a[44:47], v11, s[44:47], s62 offen offset:3072 sc1
s_add_u32 m0, s66, 151552
s_add_u32 s67, s65, 425984
buffer_load_dwordx4 v126, s[16:19], s67 offen lds
s_waitcnt lgkmcnt(4)
s_waitcnt vmcnt(19)
v_mfma_f32_32x32x16_bf16 v[32:47], v[92:95], a[8:11], v[32:47]
ds_read_b64_tr_b16 v[80:81], v5 offset:16384
ds_read_b64_tr_b16 v[82:83], v5 offset:16640
v_mfma_f32_32x32x16_bf16 v[48:63], a[8:11], v[96:99], v[48:63]
ds_read_b64_tr_b16 v[84:85], v6 offset:16384
ds_read_b64_tr_b16 v[86:87], v6 offset:16640
s_add_u32 s62, s62, 4096
buffer_load_dwordx4 a[0:3], v11, s[44:47], s62 offen offset:0 sc1
s_add_u32 m0, s66, 155648
s_add_u32 s67, s65, 458752
buffer_load_dwordx4 v126, s[16:19], s67 offen lds
s_waitcnt lgkmcnt(4)
s_waitcnt vmcnt(19)
v_mfma_f32_32x32x16_bf16 v[32:47], v[68:71], a[12:15], v[32:47]
ds_read_b64_tr_b16 v[92:93], v5 offset:17408
ds_read_b64_tr_b16 v[94:95], v5 offset:17664
v_mfma_f32_32x32x16_bf16 v[48:63], a[12:15], v[72:75], v[48:63]
ds_read_b64_tr_b16 v[96:97], v6 offset:17408
ds_read_b64_tr_b16 v[98:99], v6 offset:17664
buffer_load_dwordx4 a[4:7], v11, s[44:47], s62 offen offset:1024 sc1
s_add_u32 m0, s66, 159744
s_add_u32 s67, s65, 491520
buffer_load_dwordx4 v126, s[16:19], s67 offen lds
s_waitcnt lgkmcnt(4)
s_waitcnt vmcnt(19)
v_mfma_f32_32x32x16_bf16 v[32:47], v[80:83], a[16:19], v[32:47]
ds_read_b64_tr_b16 v[68:69], v5 offset:18432
ds_read_b64_tr_b16 v[70:71], v5 offset:18688
v_mfma_f32_32x32x16_bf16 v[48:63], a[16:19], v[84:87], v[48:63]
ds_read_b64_tr_b16 v[72:73], v6 offset:18432
ds_read_b64_tr_b16 v[74:75], v6 offset:18688
buffer_load_dwordx4 a[8:11], v11, s[44:47], s62 offen offset:2048 sc1
s_waitcnt lgkmcnt(4)
s_waitcnt vmcnt(18)
v_mfma_f32_32x32x16_bf16 v[32:47], v[92:95], a[20:23], v[32:47]
ds_read_b64_tr_b16 v[80:81], v5 offset:19456
ds_read_b64_tr_b16 v[82:83], v5 offset:19712
v_mfma_f32_32x32x16_bf16 v[48:63], a[20:23], v[96:99], v[48:63]
ds_read_b64_tr_b16 v[84:85], v6 offset:19456
ds_read_b64_tr_b16 v[86:87], v6 offset:19712
buffer_load_dwordx4 a[12:15], v11, s[44:47], s62 offen offset:3072 sc1
s_waitcnt lgkmcnt(4)
s_waitcnt vmcnt(17)
v_mfma_f32_32x32x16_bf16 v[32:47], v[68:71], a[24:27], v[32:47]
ds_read_b64_tr_b16 v[92:93], v5 offset:20480
ds_read_b64_tr_b16 v[94:95], v5 offset:20736
v_mfma_f32_32x32x16_bf16 v[48:63], a[24:27], v[72:75], v[48:63]
ds_read_b64_tr_b16 v[96:97], v6 offset:20480
ds_read_b64_tr_b16 v[98:99], v6 offset:20736
s_add_u32 s62, s62, 4096
buffer_load_dwordx4 a[16:19], v11, s[44:47], s62 offen offset:0 sc1
s_waitcnt lgkmcnt(4)
s_waitcnt vmcnt(16)
v_mfma_f32_32x32x16_bf16 v[32:47], v[80:83], a[28:31], v[32:47]
ds_read_b64_tr_b16 v[68:69], v5 offset:21504
ds_read_b64_tr_b16 v[70:71], v5 offset:21760
v_mfma_f32_32x32x16_bf16 v[48:63], a[28:31], v[84:87], v[48:63]
ds_read_b64_tr_b16 v[72:73], v6 offset:21504
ds_read_b64_tr_b16 v[74:75], v6 offset:21760
buffer_load_dwordx4 a[20:23], v11, s[44:47], s62 offen offset:1024 sc1
s_waitcnt lgkmcnt(4)
s_waitcnt vmcnt(15)
v_mfma_f32_32x32x16_bf16 v[32:47], v[92:95], a[32:35], v[32:47]
ds_read_b64_tr_b16 v[80:81], v5 offset:22528
ds_read_b64_tr_b16 v[82:83], v5 offset:22784
v_mfma_f32_32x32x16_bf16 v[48:63], a[32:35], v[96:99], v[48:63]
ds_read_b64_tr_b16 v[84:85], v6 offset:22528
ds_read_b64_tr_b16 v[86:87], v6 offset:22784
buffer_load_dwordx4 a[24:27], v11, s[44:47], s62 offen offset:2048 sc1
s_waitcnt lgkmcnt(4)
s_waitcnt vmcnt(14)
v_mfma_f32_32x32x16_bf16 v[32:47], v[68:71], a[36:39], v[32:47]
ds_read_b64_tr_b16 v[92:93], v5 offset:23552
ds_read_b64_tr_b16 v[94:95], v5 offset:23808
v_mfma_f32_32x32x16_bf16 v[48:63], a[36:39], v[72:75], v[48:63]
ds_read_b64_tr_b16 v[96:97], v6 offset:23552
ds_read_b64_tr_b16 v[98:99], v6 offset:23808
buffer_load_dwordx4 a[28:31], v11, s[44:47], s62 offen offset:3072 sc1
s_waitcnt lgkmcnt(4)
s_waitcnt vmcnt(13)
v_mfma_f32_32x32x16_bf16 v[32:47], v[80:83], a[40:43], v[32:47]
ds_read_b64_tr_b16 v[68:69], v5 offset:24576
ds_read_b64_tr_b16 v[70:71], v5 offset:24832
v_mfma_f32_32x32x16_bf16 v[48:63], a[40:43], v[84:87], v[48:63]
ds_read_b64_tr_b16 v[72:73], v6 offset:24576
ds_read_b64_tr_b16 v[74:75], v6 offset:24832
s_waitcnt lgkmcnt(4)
s_waitcnt vmcnt(11)
v_mfma_f32_32x32x16_bf16 v[32:47], v[92:95], a[44:47], v[32:47]
ds_read_b64_tr_b16 v[80:81], v5 offset:25600
ds_read_b64_tr_b16 v[82:83], v5 offset:25856
v_mfma_f32_32x32x16_bf16 v[48:63], a[44:47], v[96:99], v[48:63]
ds_read_b64_tr_b16 v[84:85], v6 offset:25600
ds_read_b64_tr_b16 v[86:87], v6 offset:25856
s_waitcnt lgkmcnt(4)
s_waitcnt vmcnt(9)
v_mfma_f32_32x32x16_bf16 v[32:47], v[68:71], a[0:3], v[32:47]
ds_read_b64_tr_b16 v[92:93], v5 offset:26624
ds_read_b64_tr_b16 v[94:95], v5 offset:26880
v_mfma_f32_32x32x16_bf16 v[48:63], a[0:3], v[72:75], v[48:63]
ds_read_b64_tr_b16 v[96:97], v6 offset:26624
ds_read_b64_tr_b16 v[98:99], v6 offset:26880
s_waitcnt lgkmcnt(4)
s_waitcnt vmcnt(7)
v_mfma_f32_32x32x16_bf16 v[32:47], v[80:83], a[4:7], v[32:47]
ds_read_b64_tr_b16 v[68:69], v5 offset:27648
ds_read_b64_tr_b16 v[70:71], v5 offset:27904
v_mfma_f32_32x32x16_bf16 v[48:63], a[4:7], v[84:87], v[48:63]
ds_read_b64_tr_b16 v[72:73], v6 offset:27648
ds_read_b64_tr_b16 v[74:75], v6 offset:27904
s_waitcnt lgkmcnt(4)
s_waitcnt vmcnt(5)
v_mfma_f32_32x32x16_bf16 v[32:47], v[92:95], a[8:11], v[32:47]
ds_read_b64_tr_b16 v[80:81], v5 offset:28672
ds_read_b64_tr_b16 v[82:83], v5 offset:28928
v_mfma_f32_32x32x16_bf16 v[48:63], a[8:11], v[96:99], v[48:63]
ds_read_b64_tr_b16 v[84:85], v6 offset:28672
ds_read_b64_tr_b16 v[86:87], v6 offset:28928
s_waitcnt lgkmcnt(4)
s_waitcnt vmcnt(4)
v_mfma_f32_32x32x16_bf16 v[32:47], v[68:71], a[12:15], v[32:47]
ds_read_b64_tr_b16 v[92:93], v5 offset:29696
ds_read_b64_tr_b16 v[94:95], v5 offset:29952
v_mfma_f32_32x32x16_bf16 v[48:63], a[12:15], v[72:75], v[48:63]
ds_read_b64_tr_b16 v[96:97], v6 offset:29696
ds_read_b64_tr_b16 v[98:99], v6 offset:29952
s_waitcnt lgkmcnt(4)
s_waitcnt vmcnt(3)
v_mfma_f32_32x32x16_bf16 v[32:47], v[80:83], a[16:19], v[32:47]
ds_read_b64_tr_b16 v[68:69], v5 offset:30720
ds_read_b64_tr_b16 v[70:71], v5 offset:30976
v_mfma_f32_32x32x16_bf16 v[48:63], a[16:19], v[84:87], v[48:63]
ds_read_b64_tr_b16 v[72:73], v6 offset:30720
ds_read_b64_tr_b16 v[74:75], v6 offset:30976
s_waitcnt lgkmcnt(4)
s_waitcnt vmcnt(2)
v_mfma_f32_32x32x16_bf16 v[32:47], v[92:95], a[20:23], v[32:47]
ds_read_b64_tr_b16 v[80:81], v5 offset:31744
ds_read_b64_tr_b16 v[82:83], v5 offset:32000
v_mfma_f32_32x32x16_bf16 v[48:63], a[20:23], v[96:99], v[48:63]
ds_read_b64_tr_b16 v[84:85], v6 offset:31744
ds_read_b64_tr_b16 v[86:87], v6 offset:32000
s_waitcnt lgkmcnt(4)
s_waitcnt vmcnt(1)
v_mfma_f32_32x32x16_bf16 v[32:47], v[68:71], a[24:27], v[32:47]
v_mfma_f32_32x32x16_bf16 v[48:63], a[24:27], v[72:75], v[48:63]
s_waitcnt lgkmcnt(0)
s_waitcnt vmcnt(0)
v_mfma_f32_32x32x16_bf16 v[32:47], v[80:83], a[28:31], v[32:47]
v_mfma_f32_32x32x16_bf16 v[48:63], a[28:31], v[84:87], v[48:63]
Lp1j_25:
s_nop 15
v_cvt_pk_bf16_f32 v64, v32, v33
v_cvt_pk_bf16_f32 v65, v34, v35
v_cvt_pk_bf16_f32 v66, v36, v37
v_cvt_pk_bf16_f32 v67, v38, v39
v_cvt_pk_bf16_f32 v68, v40, v41
v_cvt_pk_bf16_f32 v69, v42, v43
v_cvt_pk_bf16_f32 v70, v44, v45
v_cvt_pk_bf16_f32 v71, v46, v47
v_cvt_pk_bf16_f32 v72, v48, v49
v_cvt_pk_bf16_f32 v73, v50, v51
v_cvt_pk_bf16_f32 v74, v52, v53
v_cvt_pk_bf16_f32 v75, v54, v55
v_cvt_pk_bf16_f32 v76, v56, v57
v_cvt_pk_bf16_f32 v77, v58, v59
v_cvt_pk_bf16_f32 v78, v60, v61
v_cvt_pk_bf16_f32 v79, v62, v63
v_and_b32 v8, 31, v1
v_lshrrev_b32 v9, 5, v1
v_bfe_u32 v5, v1, 2, 2
v_xor_b32 v9, v9, v5
v_lshlrev_b32 v7, 6, v8
v_lshl_add_u32 v12, v9, 4, v7
v_xor_b32 v9, 2, v9
v_lshl_add_u32 v13, v9, 4, v7
s_xor_b32 s63, s58, 1
s_lshl_b32 s63, s63, 14
s_lshl_b32 s64, s57, 11
s_add_u32 s63, s63, s64
s_add_u32 s61, s63, 0
s_add_u32 s62, s63, 24576
v_add_u32 v8, s61, v12
v_add_u32 v9, s61, v13
v_add_u32 v5, s62, v12
v_add_u32 v7, s62, v13
s_lshl_b32 s61, s56, 14
s_lshl_b32 s62, s57, 12
s_add_u32 s61, s61, s62
s_add_u32 s61, s61, 1048576
s_lshl_b32 s65, s56, 4
s_lshl_b32 s62, s57, 2
s_add_u32 s65, s65, s62
s_add_u32 s65, s65, 131072
v_mov_b32 v14, s53
v_mov_b32 v15, 0
s_and_b32 s66, s50, 1
s_cmp_lg_u32 s66, s58
s_cbranch_scc1 Lfetch_26
s_cmp_eq_u32 s55, 0
s_cbranch_scc1 Ssl_28
buffer_store_dwordx4 v[64:67], v12, s[44:47], s61 offen
buffer_store_dwordx4 v[68:71], v13, s[44:47], s61 offen
buffer_store_dwordx4 v[72:75], v12, s[44:47], s61 offen offset:2048
buffer_store_dwordx4 v[76:79], v13, s[44:47], s61 offen offset:2048
s_waitcnt vmcnt(0)
s_mov_b64 exec, 1
buffer_store_dword v14, v15, s[44:47], s65 offen
s_mov_b64 exec, -1
s_branch Sen_29
Ssl_28:
buffer_store_dwordx4 v[64:67], v12, s[44:47], s61 offen sc1
buffer_store_dwordx4 v[68:71], v13, s[44:47], s61 offen sc1
buffer_store_dwordx4 v[72:75], v12, s[44:47], s61 offen offset:2048 sc1
buffer_store_dwordx4 v[76:79], v13, s[44:47], s61 offen offset:2048 sc1
s_waitcnt vmcnt(0)
s_mov_b64 exec, 1
buffer_store_dword v14, v15, s[44:47], s65 offen sc1
s_mov_b64 exec, -1
Sen_29:
s_barrier
s_branch Lp2j_27
Lfetch_26:
s_xor_b32 s65, s65, 256
s_xor_b32 s61, s61, 262144
s_mov_b32 s71, 0
P_30:
buffer_load_dword v80, v15, s[44:47], s65 offen sc1
s_add_u32 s71, s71, 1
s_cmp_gt_u32 s71, 400000
s_cbranch_scc1 Po_31
s_waitcnt vmcnt(0)
v_cmp_ne_u32 vcc, s53, v80
s_nop 0
s_cbranch_vccz Po_31
s_sleep 2
s_branch P_30
Po_31:
s_waitcnt vmcnt(0)
s_barrier
s_add_u32 m0, s64, 8192
s_nop 0
buffer_load_dwordx4 v11, s[44:47], s61 offen offset:0 sc1 lds
s_add_u32 m0, s64, 30720
s_nop 0
buffer_load_dwordx4 v11, s[44:47], s61 offen offset:2048 sc1 lds
s_add_u32 m0, s64, 8192
s_nop 0
buffer_load_dwordx4 v11, s[44:47], s61 offen offset:1024 sc1 lds
s_add_u32 m0, s64, 30720
s_nop 0
buffer_load_dwordx4 v11, s[44:47], s61 offen offset:3072 sc1 lds
Lp2j_27:
ds_write_b128 v8, v[64:67]
ds_write_b128 v9, v[68:71]
ds_write_b128 v5, v[72:75]
ds_write_b128 v7, v[76:79]
s_cmp_ge_u32 s52, 4
s_cbranch_scc1 Lq0_32
s_mov_b32 s60, 0x3eb8aa3b
v_mul_f32 v16, s60, v16
v_mul_f32 v17, s60, v17
v_mul_f32 v18, s60, v18
v_mul_f32 v19, s60, v19
v_mul_f32 v20, s60, v20
v_mul_f32 v21, s60, v21
v_mul_f32 v22, s60, v22
v_mul_f32 v23, s60, v23
v_mul_f32 v24, s60, v24
v_mul_f32 v25, s60, v25
v_mul_f32 v26, s60, v26
v_mul_f32 v27, s60, v27
v_mul_f32 v28, s60, v28
v_mul_f32 v29, s60, v29
v_mul_f32 v30, s60, v30
v_mul_f32 v31, s60, v31
v_cvt_pk_bf16_f32 v140, v16, v17
v_cvt_pk_bf16_f32 v141, v18, v19
v_cvt_pk_bf16_f32 v142, v20, v21
v_cvt_pk_bf16_f32 v143, v22, v23
v_cvt_pk_bf16_f32 v80, v24, v25
v_cvt_pk_bf16_f32 v81, v26, v27
v_cvt_pk_bf16_f32 v82, v28, v29
v_cvt_pk_bf16_f32 v83, v30, v31
s_lshl_b32 s64, s52, 10
s_add_u32 s64, s64, 49152
v_add_u32 v5, s64, v11
ds_write_b128 v5, v[80:83]
Lq0_32:
s_waitcnt vmcnt(0) lgkmcnt(0)
s_barrier
s_cmp_lt_u32 s52, 4
s_cbranch_scc1 Lwo_34
s_lshl_b32 s64, s57, 10
s_add_u32 s64, s64, 49152
v_add_u32 v5, s64, v11
ds_read_b128 v[140:143], v5
Lwo_34:
Lq_33:
s_waitcnt lgkmcnt(0)
s_cmp_ge_u32 s57, 2
s_cselect_b32 s72, s24, s20
s_cselect_b32 s73, s25, s21
s_cselect_b32 s76, 14464, 0
s_mov_b32 s74, 1835008
s_mov_b32 s75, 0x20000
s_mov_b32 s84, 4682
s_and_b32 s86, s52, 1
s_mul_i32 s85, s86, 114688
s_mul_i32 s87, s51, 224
s_add_u32 s85, s85, s87
s_mul_i32 s86, s86, 7168
s_add_u32 s76, s76, s86
v_add_u32 v12, 0, v1
v_mul_u32_u24 v13, s84, v12
v_lshrrev_b32 v13, 16, v13
v_mul_u32_u24 v144, 14, v13
v_sub_u32 v12, v12, v144
v_mul_u32_u24 v144, 3584, v13
v_lshl_add_u32 v144, v12, 4, v144
v_add_u32 v12, 64, v1
v_mul_u32_u24 v13, s84, v12
v_lshrrev_b32 v13, 16, v13
v_mul_u32_u24 v145, 14, v13
v_sub_u32 v12, v12, v145
v_mul_u32_u24 v145, 3584, v13
v_lshl_add_u32 v145, v12, 4, v145
v_add_u32 v12, 128, v1
v_mul_u32_u24 v13, s84, v12
v_lshrrev_b32 v13, 16, v13
v_mul_u32_u24 v146, 14, v13
v_sub_u32 v12, v12, v146
v_mul_u32_u24 v146, 3584, v13
v_lshl_add_u32 v146, v12, 4, v146
v_add_u32 v12, 192, v1
v_mul_u32_u24 v13, s84, v12
v_lshrrev_b32 v13, 16, v13
v_mul_u32_u24 v147, 14, v13
v_sub_u32 v12, v12, v147
v_mul_u32_u24 v147, 3584, v13
v_lshl_add_u32 v147, v12, 4, v147
v_add_u32 v12, 256, v1
v_mul_u32_u24 v13, s84, v12
v_lshrrev_b32 v13, 16, v13
v_mul_u32_u24 v148, 14, v13
v_sub_u32 v12, v12, v148
v_mul_u32_u24 v148, 3584, v13
v_lshl_add_u32 v148, v12, 4, v148
v_add_u32 v12, 320, v1
v_mul_u32_u24 v13, s84, v12
v_lshrrev_b32 v13, 16, v13
v_mul_u32_u24 v149, 14, v13
v_sub_u32 v12, v12, v149
v_mul_u32_u24 v149, 3584, v13
v_lshl_add_u32 v149, v12, 4, v149
v_add_u32 v12, 384, v1
v_mul_u32_u24 v13, s84, v12
v_lshrrev_b32 v13, 16, v13
v_mul_u32_u24 v150, 14, v13
v_sub_u32 v12, v12, v150
v_mul_u32_u24 v150, 3584, v13
v_lshl_add_u32 v150, v12, 4, v150
s_cmp_lt_u32 s52, 4
s_cbranch_scc1 Lgh_35
s_add_u32 s86, s85, 0
s_add_u32 m0, s76, 57344
s_nop 0
buffer_load_dwordx4 v144, s[72:75], s86 offen lds
s_add_u32 s86, s85, 0
s_add_u32 m0, s76, 58368
s_nop 0
buffer_load_dwordx4 v145, s[72:75], s86 offen lds
s_add_u32 s86, s85, 0
s_add_u32 m0, s76, 59392
s_nop 0
buffer_load_dwordx4 v146, s[72:75], s86 offen lds
s_add_u32 s86, s85, 0
s_add_u32 m0, s76, 60416
s_nop 0
buffer_load_dwordx4 v147, s[72:75], s86 offen lds
s_add_u32 s86, s85, 0
s_add_u32 m0, s76, 61440
s_nop 0
buffer_load_dwordx4 v148, s[72:75], s86 offen lds
s_add_u32 s86, s85, 0
s_add_u32 m0, s76, 62464
s_nop 0
buffer_load_dwordx4 v149, s[72:75], s86 offen lds
s_add_u32 s86, s85, 0
s_add_u32 m0, s76, 63488
s_nop 0
buffer_load_dwordx4 v150, s[72:75], s86 offen lds
Lgh_35:
s_lshr_b32 s60, s52, 1
s_cmp_lg_u32 s60, 1
s_cbranch_scc1 Lmall_36
s_lshl_b32 s60, s56, 1
s_and_b32 s61, s52, 1
s_add_u32 s60, s60, s61
s_lshl_b32 s60, s60, 13
s_add_u32 s61, s60, 688128
s_sub_u32 s62, s60, 1146880
s_cmp_lt_u32 s62, 1146880
s_cselect_b32 s62, s62, 0x7fff0000
s_add_u32 s62, s62, 688128
s_sub_u32 s63, s60, 2293760
s_min_u32 s63, s63, 0x7fff0000
buffer_load_dword v2, v10, s[20:23], s61 offen
buffer_load_dword v2, v10, s[24:27], s62 offen
buffer_load_dword v2, v10, s[28:31], s63 offen
Lmall_36:
s_mov_b32 s101, 0
s_cmp_lg_u32 s2, 0
s_cbranch_scc1 Lep_37
s_cmp_lg_u32 s52, 7
s_cbranch_scc1 Lep_37
v_lshlrev_b32 v124, 3, v1
s_mov_b32 s60, 4096
buffer_load_dword v125, v124, s[44:47], s60 offen offset:4 sc1
buffer_load_dword v126, v124, s[44:47], s60 offen offset:516 sc1
buffer_load_dword v127, v124, s[44:47], s60 offen offset:1028 sc1
buffer_load_dword v128, v124, s[44:47], s60 offen offset:1540 sc1
Lep_37:
v_and_b32 v8, 31, v1
v_lshrrev_b32 v9, 5, v1
v_bfe_u32 v7, v1, 2, 2
s_lshl_b32 s60, s58, 1
v_or_b32 v12, s60, v9
v_xor_b32 v12, v12, v7
v_lshlrev_b32 v4, 6, v8
v_lshl_add_u32 v4, v12, 4, v4
s_lshl_b32 s61, s57, 11
s_add_u32 s62, s61, 0
v_add_u32 v4, s62, v4
v_and_b32 v13, 15, v1
v_lshlrev_b32 v5, 6, v13
v_xor_b32 v12, v9, v7
v_lshl_add_u32 v5, v12, 4, v5
v_xor_b32 v12, 2, v12
v_lshlrev_b32 v6, 6, v13
v_lshl_add_u32 v6, v12, 4, v6
s_lshl_b32 s62, s58, 10
s_add_u32 s62, s62, s61
s_add_u32 s62, s62, 24576
v_add_u32 v5, s62, v5
v_add_u32 v6, s62, v6
s_lshl_b32 s60, s50, 2
s_add_u32 s60, s60, s57
s_sub_u32 s59, 8, s60
s_cmp_ge_u32 s60, 8
s_cselect_b32 s59, 0, s59
s_mul_i32 s92, s49, 35840
s_min_u32 s93, s52, 4
s_lshl_b32 s93, s93, 13
s_add_u32 s92, s92, s93
s_add_u32 s92, s92, 688128
ds_read_b128 a[32:35], v4 offset:16384
ds_read_b128 a[0:3], v4 offset:0
ds_read_b128 a[28:31], v4 offset:14336
ds_read_b128 a[24:27], v4 offset:12288
ds_read_b128 a[20:23], v4 offset:10240
ds_read_b128 a[16:19], v4 offset:8192
ds_read_b128 a[12:15], v4 offset:6144
ds_read_b128 a[8:11], v4 offset:4096
ds_read_b128 a[4:7], v4 offset:2048
v_lshlrev_b32 v12, 2, v9
v_sub_u32 v12, v8, v12
v_cmp_le_i32 s[60:61], 0, v12
v_cmp_le_i32 s[62:63], 1, v12
v_cmp_le_i32 s[64:65], 2, v12
v_cmp_le_i32 s[66:67], 3, v12
v_cmp_le_i32 s[68:69], 8, v12
v_cmp_le_i32 s[70:71], 9, v12
v_cmp_le_i32 s[72:73], 10, v12
v_cmp_le_i32 s[74:75], 11, v12
v_cmp_le_i32 s[76:77], 16, v12
v_cmp_le_i32 s[78:79], 17, v12
v_cmp_le_i32 s[80:81], 18, v12
v_cmp_le_i32 s[82:83], 19, v12
v_cmp_le_i32 s[84:85], 24, v12
v_cmp_le_i32 s[86:87], 25, v12
v_cmp_le_i32 s[88:89], 26, v12
v_cmp_le_i32 s[90:91], 27, v12
v_mov_b32 v13, 0xffff
v_mov_b32 v7, 0xffff0000
v_cndmask_b32 v96, 0, v13, s[60:61]
v_cndmask_b32 v12, 0, v7, s[62:63]
v_or_b32 v96, v96, v12
v_cndmask_b32 v97, 0, v13, s[64:65]
v_cndmask_b32 v12, 0, v7, s[66:67]
v_or_b32 v97, v97, v12
v_cndmask_b32 v98, 0, v13, s[68:69]
v_cndmask_b32 v12, 0, v7, s[70:71]
v_or_b32 v98, v98, v12
v_cndmask_b32 v99, 0, v13, s[72:73]
v_cndmask_b32 v12, 0, v7, s[74:75]
v_or_b32 v99, v99, v12
v_cndmask_b32 v100, 0, v13, s[76:77]
v_cndmask_b32 v12, 0, v7, s[78:79]
v_or_b32 v100, v100, v12
v_cndmask_b32 v101, 0, v13, s[80:81]
v_cndmask_b32 v12, 0, v7, s[82:83]
v_or_b32 v101, v101, v12
v_cndmask_b32 v102, 0, v13, s[84:85]
v_cndmask_b32 v12, 0, v7, s[86:87]
v_or_b32 v102, v102, v12
v_cndmask_b32 v103, 0, v13, s[88:89]
v_cndmask_b32 v12, 0, v7, s[90:91]
v_or_b32 v103, v103, v12
v_and_b32 v12, 27, v1
v_cmp_eq_u32 vcc, 16, v12
v_mov_b32 v13, 0x3f803f80
s_nop 0
v_cndmask_b32 v108, 0, v13, vcc
v_cndmask_b32 v109, 0, v13, vcc
v_cndmask_b32 v110, 0, v13, vcc
v_cndmask_b32 v111, 0, v13, vcc
v_cndmask_b32 v112, 0, v13, vcc
v_cndmask_b32 v113, 0, v13, vcc
v_cndmask_b32 v114, 0, v13, vcc
v_cndmask_b32 v115, 0, v13, vcc
v_cndmask_b32 v116, 0, v13, vcc
v_cndmask_b32 v117, 0, v13, vcc
v_cndmask_b32 v118, 0, v13, vcc
v_cndmask_b32 v119, 0, v13, vcc
v_cndmask_b32 v120, 0, v13, vcc
v_cndmask_b32 v121, 0, v13, vcc
v_cndmask_b32 v122, 0, v13, vcc
v_cndmask_b32 v123, 0, v13, vcc
s_waitcnt lgkmcnt(7)
v_mfma_f32_32x32x16_bf16 v[16:31], a[32:35], v[140:143], 0
v_mfma_f32_32x32x16_bf16 v[32:47], a[0:3], v[140:143], 0
s_cmp_eq_u32 s59, 0
s_cbranch_scc1 Lnt_38
s_nop 12
v_mov_b32 v32, 0xf149f2ca
v_mov_b32 v33, 0xf149f2ca
v_mov_b32 v34, 0xf149f2ca
v_mov_b32 v35, 0xf149f2ca
v_mov_b32 v36, 0xf149f2ca
v_mov_b32 v37, 0xf149f2ca
v_mov_b32 v38, 0xf149f2ca
v_mov_b32 v39, 0xf149f2ca
v_mov_b32 v40, 0xf149f2ca
v_mov_b32 v41, 0xf149f2ca
v_mov_b32 v42, 0xf149f2ca
v_mov_b32 v43, 0xf149f2ca
v_mov_b32 v44, 0xf149f2ca
v_mov_b32 v45, 0xf149f2ca
v_mov_b32 v46, 0xf149f2ca
v_mov_b32 v47, 0xf149f2ca
Lnt_38:
s_nop 12
v_cndmask_b32 v16, v32, v16, s[60:61]
v_cndmask_b32 v17, v33, v17, s[62:63]
v_cndmask_b32 v18, v34, v18, s[64:65]
v_cndmask_b32 v19, v35, v19, s[66:67]
v_cndmask_b32 v20, v36, v20, s[68:69]
v_cndmask_b32 v21, v37, v21, s[70:71]
v_cndmask_b32 v22, v38, v22, s[72:73]
v_cndmask_b32 v23, v39, v23, s[74:75]
v_cndmask_b32 v24, v40, v24, s[76:77]
v_cndmask_b32 v25, v41, v25, s[78:79]
v_cndmask_b32 v26, v42, v26, s[80:81]
v_cndmask_b32 v27, v43, v27, s[82:83]
v_cndmask_b32 v28, v44, v28, s[84:85]
v_cndmask_b32 v29, v45, v29, s[86:87]
v_cndmask_b32 v30, v46, v30, s[88:89]
v_cndmask_b32 v31, v47, v31, s[90:91]
s_waitcnt lgkmcnt(6)
v_mfma_f32_32x32x16_bf16 v[32:47], a[28:31], v[140:143], 0
v_max3_f32 v104, v16, v17, v18
v_max3_f32 v104, v104, v19, v20
v_max3_f32 v104, v104, v21, v22
v_max3_f32 v104, v104, v23, v24
v_max3_f32 v104, v104, v25, v26
v_max3_f32 v104, v104, v27, v28
v_max3_f32 v104, v104, v29, v30
v_max_f32 v104, v104, v31
s_cmp_gt_u32 s59, 7
s_cbranch_scc1 Lp1e_39
s_waitcnt lgkmcnt(5)
v_mfma_f32_32x32x16_bf16 v[16:31], a[24:27], v[140:143], 0
v_max3_f32 v104, v104, v32, v33
v_max3_f32 v104, v104, v34, v35
v_max3_f32 v104, v104, v36, v37
v_max3_f32 v104, v104, v38, v39
v_max3_f32 v104, v104, v40, v41
v_max3_f32 v104, v104, v42, v43
v_max3_f32 v104, v104, v44, v45
v_max3_f32 v104, v104, v46, v47
s_cmp_gt_u32 s59, 6
s_cbranch_scc1 Lp1e_39
s_waitcnt lgkmcnt(4)
v_mfma_f32_32x32x16_bf16 v[32:47], a[20:23], v[140:143], 0
v_max3_f32 v104, v104, v16, v17
v_max3_f32 v104, v104, v18, v19
v_max3_f32 v104, v104, v20, v21
v_max3_f32 v104, v104, v22, v23
v_max3_f32 v104, v104, v24, v25
v_max3_f32 v104, v104, v26, v27
v_max3_f32 v104, v104, v28, v29
v_max3_f32 v104, v104, v30, v31
s_cmp_gt_u32 s59, 5
s_cbranch_scc1 Lp1e_39
s_waitcnt lgkmcnt(3)
v_mfma_f32_32x32x16_bf16 v[16:31], a[16:19], v[140:143], 0
v_max3_f32 v104, v104, v32, v33
v_max3_f32 v104, v104, v34, v35
v_max3_f32 v104, v104, v36, v37
v_max3_f32 v104, v104, v38, v39
v_max3_f32 v104, v104, v40, v41
v_max3_f32 v104, v104, v42, v43
v_max3_f32 v104, v104, v44, v45
v_max3_f32 v104, v104, v46, v47
s_cmp_gt_u32 s59, 4
s_cbranch_scc1 Lp1e_39
s_waitcnt lgkmcnt(2)
v_mfma_f32_32x32x16_bf16 v[32:47], a[12:15], v[140:143], 0
v_max3_f32 v104, v104, v16, v17
v_max3_f32 v104, v104, v18, v19
v_max3_f32 v104, v104, v20, v21
v_max3_f32 v104, v104, v22, v23
v_max3_f32 v104, v104, v24, v25
v_max3_f32 v104, v104, v26, v27
v_max3_f32 v104, v104, v28, v29
v_max3_f32 v104, v104, v30, v31
s_cmp_gt_u32 s59, 3
s_cbranch_scc1 Lp1e_39
s_waitcnt lgkmcnt(1)
v_mfma_f32_32x32x16_bf16 v[16:31], a[8:11], v[140:143], 0
v_max3_f32 v104, v104, v32, v33
v_max3_f32 v104, v104, v34, v35
v_max3_f32 v104, v104, v36, v37
v_max3_f32 v104, v104, v38, v39
v_max3_f32 v104, v104, v40, v41
v_max3_f32 v104, v104, v42, v43
v_max3_f32 v104, v104, v44, v45
v_max3_f32 v104, v104, v46, v47
s_cmp_gt_u32 s59, 2
s_cbranch_scc1 Lp1e_39
s_waitcnt lgkmcnt(0)
v_mfma_f32_32x32x16_bf16 v[32:47], a[4:7], v[140:143], 0
v_max3_f32 v104, v104, v16, v17
v_max3_f32 v104, v104, v18, v19
v_max3_f32 v104, v104, v20, v21
v_max3_f32 v104, v104, v22, v23
v_max3_f32 v104, v104, v24, v25
v_max3_f32 v104, v104, v26, v27
v_max3_f32 v104, v104, v28, v29
v_max3_f32 v104, v104, v30, v31
s_cmp_gt_u32 s59, 1
s_cbranch_scc1 Lp1e_39
s_nop 1
v_max3_f32 v104, v104, v32, v33
v_max3_f32 v104, v104, v34, v35
v_max3_f32 v104, v104, v36, v37
v_max3_f32 v104, v104, v38, v39
v_max3_f32 v104, v104, v40, v41
v_max3_f32 v104, v104, v42, v43
v_max3_f32 v104, v104, v44, v45
v_max3_f32 v104, v104, v46, v47
Lp1e_39:
s_waitcnt lgkmcnt(0)
s_nop 12
v_mov_b32 v105, v104
s_nop 1
v_permlane32_swap_b32 v104, v105
v_max_f32 v104, v104, v105
v_sub_f32 v48, 0, v104
v_sub_f32 v49, 0, v104
v_sub_f32 v50, 0, v104
v_sub_f32 v51, 0, v104
v_sub_f32 v52, 0, v104
v_sub_f32 v53, 0, v104
v_sub_f32 v54, 0, v104
v_sub_f32 v55, 0, v104
v_sub_f32 v56, 0, v104
v_sub_f32 v57, 0, v104
v_sub_f32 v58, 0, v104
v_sub_f32 v59, 0, v104
v_sub_f32 v60, 0, v104
v_sub_f32 v61, 0, v104
v_sub_f32 v62, 0, v104
v_sub_f32 v63, 0, v104
s_mov_b32 exec_lo, 0xffff
s_mov_b32 exec_hi, 0xffff
ds_read_b128 v[108:111], v5 offset:16384
ds_read_b128 v[112:115], v6 offset:16384
s_mov_b64 exec, -1
s_mov_b32 exec_lo, 0xffff
s_mov_b32 exec_hi, 0xffff
ds_read_b128 v[116:119], v5 offset:0
ds_read_b128 v[120:123], v6 offset:0
s_mov_b64 exec, -1
v_mfma_f32_32x32x16_bf16 v[16:31], a[32:35], v[140:143], v[48:63]
v_mfma_f32_32x32x16_bf16 v[32:47], a[0:3], v[140:143], v[48:63]
s_cmp_eq_u32 s59, 0
s_cbranch_scc1 Lnt_40
s_nop 12
v_mov_b32 v32, 0xf149f2ca
v_mov_b32 v33, 0xf149f2ca
v_mov_b32 v34, 0xf149f2ca
v_mov_b32 v35, 0xf149f2ca
v_mov_b32 v36, 0xf149f2ca
v_mov_b32 v37, 0xf149f2ca
v_mov_b32 v38, 0xf149f2ca
v_mov_b32 v39, 0xf149f2ca
v_mov_b32 v40, 0xf149f2ca
v_mov_b32 v41, 0xf149f2ca
v_mov_b32 v42, 0xf149f2ca
v_mov_b32 v43, 0xf149f2ca
v_mov_b32 v44, 0xf149f2ca
v_mov_b32 v45, 0xf149f2ca
v_mov_b32 v46, 0xf149f2ca
v_mov_b32 v47, 0xf149f2ca
Lnt_40:
s_nop 12
v_cndmask_b32 v16, v32, v16, s[60:61]
v_cndmask_b32 v17, v33, v17, s[62:63]
v_cndmask_b32 v18, v34, v18, s[64:65]
v_cndmask_b32 v19, v35, v19, s[66:67]
v_cndmask_b32 v20, v36, v20, s[68:69]
v_cndmask_b32 v21, v37, v21, s[70:71]
v_cndmask_b32 v22, v38, v22, s[72:73]
v_cndmask_b32 v23, v39, v23, s[74:75]
v_cndmask_b32 v24, v40, v24, s[76:77]
v_cndmask_b32 v25, v41, v25, s[78:79]
v_cndmask_b32 v26, v42, v26, s[80:81]
v_cndmask_b32 v27, v43, v27, s[82:83]
v_cndmask_b32 v28, v44, v28, s[84:85]
v_cndmask_b32 v29, v45, v29, s[86:87]
v_cndmask_b32 v30, v46, v30, s[88:89]
v_cndmask_b32 v31, v47, v31, s[90:91]
v_mfma_f32_32x32x16_bf16 v[32:47], a[28:31], v[140:143], v[48:63]
v_exp_f32 v16, v16
v_exp_f32 v17, v17
v_exp_f32 v18, v18
v_exp_f32 v19, v19
v_exp_f32 v20, v20
v_exp_f32 v21, v21
v_exp_f32 v22, v22
v_exp_f32 v23, v23
v_exp_f32 v24, v24
v_exp_f32 v25, v25
v_exp_f32 v26, v26
v_exp_f32 v27, v27
v_exp_f32 v28, v28
v_exp_f32 v29, v29
v_exp_f32 v30, v30
v_exp_f32 v31, v31
v_cvt_pk_bf16_f32 v80, v16, v17
v_cvt_pk_bf16_f32 v81, v18, v19
v_cvt_pk_bf16_f32 v82, v20, v21
v_cvt_pk_bf16_f32 v83, v22, v23
v_cvt_pk_bf16_f32 v84, v24, v25
v_cvt_pk_bf16_f32 v85, v26, v27
v_cvt_pk_bf16_f32 v86, v28, v29
v_cvt_pk_bf16_f32 v87, v30, v31
v_and_b32 v88, v80, v96
v_and_b32 v89, v81, v97
v_and_b32 v90, v82, v98
v_and_b32 v91, v83, v99
v_and_b32 v92, v84, v100
v_and_b32 v93, v85, v101
v_and_b32 v94, v86, v102
v_and_b32 v95, v87, v103
v_xor_b32 v80, v80, v88
v_xor_b32 v81, v81, v89
v_xor_b32 v82, v82, v90
v_xor_b32 v83, v83, v91
v_xor_b32 v84, v84, v92
v_xor_b32 v85, v85, v93
v_xor_b32 v86, v86, v94
v_xor_b32 v87, v87, v95
s_waitcnt lgkmcnt(0)
v_mfma_f32_32x32x16_bf16 v[64:79], v[108:111], v[88:91], 0
v_mfma_f32_32x32x16_bf16 v[64:79], v[112:115], v[92:95], v[64:79]
s_cmp_lg_u32 s59, 0
s_cbranch_scc1 Lnpv_41
v_mfma_f32_32x32x16_bf16 v[64:79], v[116:119], v[80:83], v[64:79]
v_mfma_f32_32x32x16_bf16 v[64:79], v[120:123], v[84:87], v[64:79]
Lnpv_41:
s_mov_b32 exec_lo, 0xffff
s_mov_b32 exec_hi, 0xffff
ds_read_b128 v[108:111], v5 offset:14336
ds_read_b128 v[112:115], v6 offset:14336
s_mov_b64 exec, -1
s_cmp_gt_u32 s59, 7
s_cbranch_scc1 Lp2e_42
v_mfma_f32_32x32x16_bf16 v[16:31], a[24:27], v[140:143], v[48:63]
s_mov_b32 exec_lo, 0xffff
s_mov_b32 exec_hi, 0xffff
ds_read_b128 v[116:119], v5 offset:12288
ds_read_b128 v[120:123], v6 offset:12288
s_mov_b64 exec, -1
v_exp_f32 v32, v32
v_exp_f32 v33, v33
v_exp_f32 v34, v34
v_exp_f32 v35, v35
v_exp_f32 v36, v36
v_exp_f32 v37, v37
v_exp_f32 v38, v38
v_exp_f32 v39, v39
v_exp_f32 v40, v40
v_exp_f32 v41, v41
v_exp_f32 v42, v42
v_exp_f32 v43, v43
v_exp_f32 v44, v44
v_exp_f32 v45, v45
v_exp_f32 v46, v46
v_exp_f32 v47, v47
v_cvt_pk_bf16_f32 v88, v32, v33
v_cvt_pk_bf16_f32 v89, v34, v35
v_cvt_pk_bf16_f32 v90, v36, v37
v_cvt_pk_bf16_f32 v91, v38, v39
v_cvt_pk_bf16_f32 v92, v40, v41
v_cvt_pk_bf16_f32 v93, v42, v43
v_cvt_pk_bf16_f32 v94, v44, v45
v_cvt_pk_bf16_f32 v95, v46, v47
s_waitcnt lgkmcnt(2)
v_mfma_f32_32x32x16_bf16 v[64:79], v[108:111], v[88:91], v[64:79]
v_mfma_f32_32x32x16_bf16 v[64:79], v[112:115], v[92:95], v[64:79]
s_cmp_gt_u32 s59, 6
s_cbranch_scc1 Lp2e_42
v_mfma_f32_32x32x16_bf16 v[32:47], a[20:23], v[140:143], v[48:63]
s_mov_b32 exec_lo, 0xffff
s_mov_b32 exec_hi, 0xffff
ds_read_b128 v[108:111], v5 offset:10240
ds_read_b128 v[112:115], v6 offset:10240
s_mov_b64 exec, -1
v_exp_f32 v16, v16
v_exp_f32 v17, v17
v_exp_f32 v18, v18
v_exp_f32 v19, v19
v_exp_f32 v20, v20
v_exp_f32 v21, v21
v_exp_f32 v22, v22
v_exp_f32 v23, v23
v_exp_f32 v24, v24
v_exp_f32 v25, v25
v_exp_f32 v26, v26
v_exp_f32 v27, v27
v_exp_f32 v28, v28
v_exp_f32 v29, v29
v_exp_f32 v30, v30
v_exp_f32 v31, v31
v_cvt_pk_bf16_f32 v80, v16, v17
v_cvt_pk_bf16_f32 v81, v18, v19
v_cvt_pk_bf16_f32 v82, v20, v21
v_cvt_pk_bf16_f32 v83, v22, v23
v_cvt_pk_bf16_f32 v84, v24, v25
v_cvt_pk_bf16_f32 v85, v26, v27
v_cvt_pk_bf16_f32 v86, v28, v29
v_cvt_pk_bf16_f32 v87, v30, v31
s_waitcnt lgkmcnt(2)
v_mfma_f32_32x32x16_bf16 v[64:79], v[116:119], v[80:83], v[64:79]
v_mfma_f32_32x32x16_bf16 v[64:79], v[120:123], v[84:87], v[64:79]
s_cmp_gt_u32 s59, 5
s_cbranch_scc1 Lp2e_42
v_mfma_f32_32x32x16_bf16 v[16:31], a[16:19], v[140:143], v[48:63]
s_mov_b32 exec_lo, 0xffff
s_mov_b32 exec_hi, 0xffff
ds_read_b128 v[116:119], v5 offset:8192
ds_read_b128 v[120:123], v6 offset:8192
s_mov_b64 exec, -1
v_exp_f32 v32, v32
v_exp_f32 v33, v33
v_exp_f32 v34, v34
v_exp_f32 v35, v35
v_exp_f32 v36, v36
v_exp_f32 v37, v37
v_exp_f32 v38, v38
v_exp_f32 v39, v39
v_exp_f32 v40, v40
v_exp_f32 v41, v41
v_exp_f32 v42, v42
v_exp_f32 v43, v43
v_exp_f32 v44, v44
v_exp_f32 v45, v45
v_exp_f32 v46, v46
v_exp_f32 v47, v47
v_cvt_pk_bf16_f32 v88, v32, v33
v_cvt_pk_bf16_f32 v89, v34, v35
v_cvt_pk_bf16_f32 v90, v36, v37
v_cvt_pk_bf16_f32 v91, v38, v39
v_cvt_pk_bf16_f32 v92, v40, v41
v_cvt_pk_bf16_f32 v93, v42, v43
v_cvt_pk_bf16_f32 v94, v44, v45
v_cvt_pk_bf16_f32 v95, v46, v47
s_waitcnt lgkmcnt(2)
v_mfma_f32_32x32x16_bf16 v[64:79], v[108:111], v[88:91], v[64:79]
v_mfma_f32_32x32x16_bf16 v[64:79], v[112:115], v[92:95], v[64:79]
s_cmp_gt_u32 s59, 4
s_cbranch_scc1 Lp2e_42
v_mfma_f32_32x32x16_bf16 v[32:47], a[12:15], v[140:143], v[48:63]
s_mov_b32 exec_lo, 0xffff
s_mov_b32 exec_hi, 0xffff
ds_read_b128 v[108:111], v5 offset:6144
ds_read_b128 v[112:115], v6 offset:6144
s_mov_b64 exec, -1
v_exp_f32 v16, v16
v_exp_f32 v17, v17
v_exp_f32 v18, v18
v_exp_f32 v19, v19
v_exp_f32 v20, v20
v_exp_f32 v21, v21
v_exp_f32 v22, v22
v_exp_f32 v23, v23
v_exp_f32 v24, v24
v_exp_f32 v25, v25
v_exp_f32 v26, v26
v_exp_f32 v27, v27
v_exp_f32 v28, v28
v_exp_f32 v29, v29
v_exp_f32 v30, v30
v_exp_f32 v31, v31
v_cvt_pk_bf16_f32 v80, v16, v17
v_cvt_pk_bf16_f32 v81, v18, v19
v_cvt_pk_bf16_f32 v82, v20, v21
v_cvt_pk_bf16_f32 v83, v22, v23
v_cvt_pk_bf16_f32 v84, v24, v25
v_cvt_pk_bf16_f32 v85, v26, v27
v_cvt_pk_bf16_f32 v86, v28, v29
v_cvt_pk_bf16_f32 v87, v30, v31
s_waitcnt lgkmcnt(2)
v_mfma_f32_32x32x16_bf16 v[64:79], v[116:119], v[80:83], v[64:79]
v_mfma_f32_32x32x16_bf16 v[64:79], v[120:123], v[84:87], v[64:79]
s_cmp_gt_u32 s59, 3
s_cbranch_scc1 Lp2e_42
v_mfma_f32_32x32x16_bf16 v[16:31], a[8:11], v[140:143], v[48:63]
s_mov_b32 exec_lo, 0xffff
s_mov_b32 exec_hi, 0xffff
ds_read_b128 v[116:119], v5 offset:4096
ds_read_b128 v[120:123], v6 offset:4096
s_mov_b64 exec, -1
v_exp_f32 v32, v32
v_exp_f32 v33, v33
v_exp_f32 v34, v34
v_exp_f32 v35, v35
v_exp_f32 v36, v36
v_exp_f32 v37, v37
v_exp_f32 v38, v38
v_exp_f32 v39, v39
v_exp_f32 v40, v40
v_exp_f32 v41, v41
v_exp_f32 v42, v42
v_exp_f32 v43, v43
v_exp_f32 v44, v44
v_exp_f32 v45, v45
v_exp_f32 v46, v46
v_exp_f32 v47, v47
v_cvt_pk_bf16_f32 v88, v32, v33
v_cvt_pk_bf16_f32 v89, v34, v35
v_cvt_pk_bf16_f32 v90, v36, v37
v_cvt_pk_bf16_f32 v91, v38, v39
v_cvt_pk_bf16_f32 v92, v40, v41
v_cvt_pk_bf16_f32 v93, v42, v43
v_cvt_pk_bf16_f32 v94, v44, v45
v_cvt_pk_bf16_f32 v95, v46, v47
s_waitcnt lgkmcnt(2)
v_mfma_f32_32x32x16_bf16 v[64:79], v[108:111], v[88:91], v[64:79]
v_mfma_f32_32x32x16_bf16 v[64:79], v[112:115], v[92:95], v[64:79]
s_cmp_gt_u32 s59, 2
s_cbranch_scc1 Lp2e_42
v_mfma_f32_32x32x16_bf16 v[32:47], a[4:7], v[140:143], v[48:63]
s_mov_b32 exec_lo, 0xffff
s_mov_b32 exec_hi, 0xffff
ds_read_b128 v[108:111], v5 offset:2048
ds_read_b128 v[112:115], v6 offset:2048
s_mov_b64 exec, -1
v_exp_f32 v16, v16
v_exp_f32 v17, v17
v_exp_f32 v18, v18
v_exp_f32 v19, v19
v_exp_f32 v20, v20
v_exp_f32 v21, v21
v_exp_f32 v22, v22
v_exp_f32 v23, v23
v_exp_f32 v24, v24
v_exp_f32 v25, v25
v_exp_f32 v26, v26
v_exp_f32 v27, v27
v_exp_f32 v28, v28
v_exp_f32 v29, v29
v_exp_f32 v30, v30
v_exp_f32 v31, v31
v_cvt_pk_bf16_f32 v80, v16, v17
v_cvt_pk_bf16_f32 v81, v18, v19
v_cvt_pk_bf16_f32 v82, v20, v21
v_cvt_pk_bf16_f32 v83, v22, v23
v_cvt_pk_bf16_f32 v84, v24, v25
v_cvt_pk_bf16_f32 v85, v26, v27
v_cvt_pk_bf16_f32 v86, v28, v29
v_cvt_pk_bf16_f32 v87, v30, v31
s_waitcnt lgkmcnt(2)
v_mfma_f32_32x32x16_bf16 v[64:79], v[116:119], v[80:83], v[64:79]
v_mfma_f32_32x32x16_bf16 v[64:79], v[120:123], v[84:87], v[64:79]
s_cmp_gt_u32 s59, 1
s_cbranch_scc1 Lp2e_42
v_exp_f32 v32, v32
v_exp_f32 v33, v33
v_exp_f32 v34, v34
v_exp_f32 v35, v35
v_exp_f32 v36, v36
v_exp_f32 v37, v37
v_exp_f32 v38, v38
v_exp_f32 v39, v39
v_exp_f32 v40, v40
v_exp_f32 v41, v41
v_exp_f32 v42, v42
v_exp_f32 v43, v43
v_exp_f32 v44, v44
v_exp_f32 v45, v45
v_exp_f32 v46, v46
v_exp_f32 v47, v47
v_cvt_pk_bf16_f32 v88, v32, v33
v_cvt_pk_bf16_f32 v89, v34, v35
v_cvt_pk_bf16_f32 v90, v36, v37
v_cvt_pk_bf16_f32 v91, v38, v39
v_cvt_pk_bf16_f32 v92, v40, v41
v_cvt_pk_bf16_f32 v93, v42, v43
v_cvt_pk_bf16_f32 v94, v44, v45
v_cvt_pk_bf16_f32 v95, v46, v47
s_waitcnt lgkmcnt(0)
v_mfma_f32_32x32x16_bf16 v[64:79], v[108:111], v[88:91], v[64:79]
v_mfma_f32_32x32x16_bf16 v[64:79], v[112:115], v[92:95], v[64:79]
Lp2e_42:
s_waitcnt lgkmcnt(0)
s_nop 15
v_rcp_f32 v104, v72
s_nop 0
v_mul_f32 v64, v104, v64
v_mul_f32 v65, v104, v65
v_mul_f32 v66, v104, v66
v_mul_f32 v67, v104, v67
v_mul_f32 v68, v104, v68
v_mul_f32 v69, v104, v69
v_mul_f32 v70, v104, v70
v_mul_f32 v71, v104, v71
v_cvt_pk_bf16_f32 v80, v64, v65
v_cvt_pk_bf16_f32 v81, v66, v67
v_cvt_pk_bf16_f32 v82, v68, v69
v_cvt_pk_bf16_f32 v83, v70, v71
s_lshl_b32 s60, s50, 2
s_add_u32 s60, s60, s57
s_lshl_b32 s60, s60, 15
s_lshl_b32 s61, s51, 11
s_add_u32 s60, s60, s61
s_lshl_b32 s61, s58, 10
s_add_u32 s60, s60, s61
s_add_u32 s60, s60, 5242880
s_lshl_b32 s61, s56, 5
s_lshl_b32 s62, s52, 2
s_add_u32 s61, s61, s62
s_add_u32 s61, s61, 147456
v_mov_b32 v14, s53
v_mov_b32 v15, 0
buffer_store_dwordx4 v[80:83], v11, s[44:47], s60 offen sc1
s_cmp_eq_u32 s55, 0
s_cbranch_scc1 Ssl_43
s_waitcnt vmcnt(0)
s_mov_b64 exec, 1
buffer_store_dword v14, v15, s[44:47], s61 offen
s_mov_b64 exec, -1
s_branch Sen_44
Ssl_43:
s_waitcnt vmcnt(0)
s_mov_b64 exec, 1
buffer_store_dword v14, v15, s[44:47], s61 offen sc1
s_mov_b64 exec, -1
Sen_44:
s_cmp_lg_u32 s2, 0
s_cbranch_scc1 Lep2_45
s_cmp_lg_u32 s52, 7
s_cbranch_scc1 Lep2_45
v_xor_b32 v125, s53, v125
v_xor_b32 v126, s53, v126
v_xor_b32 v127, s53, v127
v_xor_b32 v128, s53, v128
v_or3_b32 v125, v125, v126, v127
v_or_b32 v125, v125, v128
v_cmp_ne_u32 vcc, 0, v125
s_nop 0
s_cbranch_vccnz Lep2_45
s_mov_b32 s101, 1
s_mov_b64 exec, 1
buffer_store_dword v14, v15, s[44:47], 0 offen offset:0 sc1
s_mov_b64 exec, -1
Lep2_45:
s_cmp_ge_u32 s57, 2
s_cselect_b32 s72, s24, s20
s_cselect_b32 s73, s25, s21
s_cselect_b32 s76, 14464, 0
s_mov_b32 s74, 1835008
s_mov_b32 s75, 0x20000
s_mov_b32 s84, 4682
s_and_b32 s86, s52, 1
s_mul_i32 s85, s86, 114688
s_mul_i32 s87, s51, 224
s_add_u32 s85, s85, s87
s_mul_i32 s86, s86, 7168
s_add_u32 s76, s76, s86
s_barrier
s_lshr_b32 s63, s51, 3
s_lshl_b32 s63, s63, 1
s_and_b32 s61, s52, 1
s_add_u32 s63, s63, s61
s_lshr_b32 s65, s52, 1
s_and_b32 s67, s65, 1
s_lshl_b32 s60, s50, 9
s_lshl_b32 s61, s63, 2
s_add_u32 s60, s60, s61
s_lshl_b32 s61, s65, 7
s_add_u32 s89, s60, s61
s_lshl_b32 s61, s67, 8
s_add_u32 s60, s60, s61
s_add_u32 s60, s60, 147456
v_and_b32 v14, 3, v1
v_lshlrev_b32 v14, 5, v14
v_bfe_u32 v15, v1, 2, 1
v_lshl_add_u32 v153, v15, 4, v14
v_and_b32 v14, 7, v1
v_lshlrev_b32 v14, 5, v14
v_bfe_u32 v15, v1, 3, 1
v_lshl_add_u32 v14, v15, 4, v14
s_lshl_b32 s88, s50, 2
s_add_u32 s88, s88, s63
s_lshl_b32 s62, s88, 15
s_lshl_b32 s61, s67, 14
s_add_u32 s62, s62, s61
s_add_u32 s62, s62, 5242880
v_lshrrev_b32 v8, 5, v1
v_bfe_u32 v9, v1, 2, 2
v_lshl_add_u32 v8, v8, 3, v9
v_lshlrev_b32 v8, 7, v8
v_bfe_u32 v12, v1, 4, 1
v_lshl_add_u32 v8, v12, 5, v8
v_and_b32 v12, 1, v1
v_lshl_add_u32 v8, v12, 4, v8
v_bfe_u32 v12, v1, 1, 1
v_lshl_add_u32 v8, v12, 3, v8
v_lshrrev_b32 v9, 1, v9
v_lshl_add_u32 v154, v9, 6, v8
v_xor_b32 v9, 1, v9
v_lshl_add_u32 v155, v9, 6, v8
s_cmp_ge_u32 s52, 4
s_cselect_b64 vcc, -1, 0
v_cndmask_b32 v4, v154, v155, vcc
s_lshl_b32 s61, s67, 15
s_add_u32 s61, s61, 98304
v_add_u32 v4, s61, v4
v_and_b32 v12, 31, v1
v_lshlrev_b32 v12, 10, v12
v_lshrrev_b32 v13, 5, v1
v_lshl_add_u32 v151, v13, 4, v12
s_lshl_b32 s80, s88, 15
s_and_b32 s66, s51, 7
s_lshl_b32 s66, s66, 7
s_add_u32 s80, s80, s66
s_lshl_b32 s61, s65, 5
s_add_u32 s80, s80, s61
v_lshlrev_b32 v12, 11, v3
v_and_b32 v13, 15, v1
v_lshl_add_u32 v12, v13, 4, v12
s_lshl_b32 s66, s66, 1
s_add_u32 s66, s66, 73728
buffer_load_dwordx4 v[124:127], v151, s[8:11], s80 offen
s_cmp_lg_u32 s52, 2
s_cbranch_scc1 Ltab_46
s_mov_b32 s71, 0
T_47:
buffer_load_dwordx4 v[96:99], v12, s[44:47], s66 offen sc1
s_add_u32 s71, s71, 1
s_cmp_gt_u32 s71, 400000
s_cbranch_scc1 To_48
s_waitcnt vmcnt(0)
v_xor_b32 v100, s53, v97
v_xor_b32 v101, s53, v99
v_or_b32 v100, v100, v101
v_cmp_ne_u32 vcc, 0, v100
s_nop 0
s_cbranch_vccnz T_47
To_48:
s_waitcnt vmcnt(0)
v_and_b32 v97, 0xffff0000, v96
v_lshlrev_b32 v96, 16, v96
v_and_b32 v99, 0xffff0000, v98
v_lshlrev_b32 v98, 16, v98
v_add_u32 v12, 32768, v11
ds_write_b128 v12, v[96:99]
Ltab_46:
s_waitcnt lgkmcnt(0)
ds_read_b64_tr_b16 v[32:33], v4 offset:0
ds_read_b64_tr_b16 v[34:35], v4 offset:512
ds_read_b64_tr_b16 v[36:37], v4 offset:2048
ds_read_b64_tr_b16 v[38:39], v4 offset:2560
s_mov_b32 s71, 0
P_49:
buffer_load_dword v15, v14, s[44:47], s60 offen sc1
s_add_u32 s71, s71, 1
s_cmp_gt_u32 s71, 400000
s_cbranch_scc1 Po_50
s_waitcnt vmcnt(0)
v_cmp_ne_u32 vcc, s53, v15
s_nop 0
s_cbranch_vccz Po_50
s_sleep 2
s_branch P_49
Po_50:
s_waitcnt vmcnt(0)
buffer_load_dwordx4 a[0:3], v11, s[44:47], s62 offen offset:0
buffer_load_dwordx4 a[4:7], v11, s[44:47], s62 offen offset:1024
buffer_load_dwordx4 a[8:11], v11, s[44:47], s62 offen offset:2048
buffer_load_dwordx4 a[12:15], v11, s[44:47], s62 offen offset:3072
s_add_u32 s62, s62, 4096
buffer_load_dwordx4 a[16:19], v11, s[44:47], s62 offen offset:0
buffer_load_dwordx4 a[20:23], v11, s[44:47], s62 offen offset:1024
buffer_load_dwordx4 a[24:27], v11, s[44:47], s62 offen offset:2048
buffer_load_dwordx4 a[28:31], v11, s[44:47], s62 offen offset:3072
s_add_u32 s62, s62, 4096
buffer_load_dwordx4 a[32:35], v11, s[44:47], s62 offen offset:0
buffer_load_dwordx4 a[36:39], v11, s[44:47], s62 offen offset:1024
buffer_load_dwordx4 a[40:43], v11, s[44:47], s62 offen offset:2048
buffer_load_dwordx4 a[44:47], v11, s[44:47], s62 offen offset:3072
s_add_u32 s62, s62, 4096
buffer_load_dwordx4 a[48:51], v11, s[44:47], s62 offen offset:0
buffer_load_dwordx4 a[52:55], v11, s[44:47], s62 offen offset:1024
buffer_load_dwordx4 a[56:59], v11, s[44:47], s62 offen offset:2048
buffer_load_dwordx4 a[60:63], v11, s[44:47], s62 offen offset:3072
s_waitcnt lgkmcnt(2)
s_waitcnt vmcnt(15)
v_mfma_f32_32x32x16_bf16 v[16:31], v[32:35], a[0:3], 0
ds_read_b64_tr_b16 v[40:41], v4 offset:4096
ds_read_b64_tr_b16 v[42:43], v4 offset:4608
s_waitcnt lgkmcnt(2)
s_waitcnt vmcnt(14)
v_mfma_f32_32x32x16_bf16 v[16:31], v[36:39], a[4:7], v[16:31]
ds_read_b64_tr_b16 v[32:33], v4 offset:6144
ds_read_b64_tr_b16 v[34:35], v4 offset:6656
s_waitcnt lgkmcnt(2)
s_waitcnt vmcnt(13)
v_mfma_f32_32x32x16_bf16 v[16:31], v[40:43], a[8:11], v[16:31]
ds_read_b64_tr_b16 v[36:37], v4 offset:8192
ds_read_b64_tr_b16 v[38:39], v4 offset:8704
s_waitcnt lgkmcnt(2)
s_waitcnt vmcnt(12)
v_mfma_f32_32x32x16_bf16 v[16:31], v[32:35], a[12:15], v[16:31]
ds_read_b64_tr_b16 v[40:41], v4 offset:10240
ds_read_b64_tr_b16 v[42:43], v4 offset:10752
s_waitcnt lgkmcnt(2)
s_waitcnt vmcnt(11)
v_mfma_f32_32x32x16_bf16 v[16:31], v[36:39], a[16:19], v[16:31]
ds_read_b64_tr_b16 v[32:33], v4 offset:12288
ds_read_b64_tr_b16 v[34:35], v4 offset:12800
s_waitcnt lgkmcnt(2)
s_waitcnt vmcnt(10)
v_mfma_f32_32x32x16_bf16 v[16:31], v[40:43], a[20:23], v[16:31]
ds_read_b64_tr_b16 v[36:37], v4 offset:14336
ds_read_b64_tr_b16 v[38:39], v4 offset:14848
s_waitcnt lgkmcnt(2)
s_waitcnt vmcnt(9)
v_mfma_f32_32x32x16_bf16 v[16:31], v[32:35], a[24:27], v[16:31]
ds_read_b64_tr_b16 v[40:41], v4 offset:16384
ds_read_b64_tr_b16 v[42:43], v4 offset:16896
s_waitcnt lgkmcnt(2)
s_waitcnt vmcnt(8)
v_mfma_f32_32x32x16_bf16 v[16:31], v[36:39], a[28:31], v[16:31]
ds_read_b64_tr_b16 v[32:33], v4 offset:18432
ds_read_b64_tr_b16 v[34:35], v4 offset:18944
s_waitcnt lgkmcnt(2)
s_waitcnt vmcnt(7)
v_mfma_f32_32x32x16_bf16 v[16:31], v[40:43], a[32:35], v[16:31]
ds_read_b64_tr_b16 v[36:37], v4 offset:20480
ds_read_b64_tr_b16 v[38:39], v4 offset:20992
s_waitcnt lgkmcnt(2)
s_waitcnt vmcnt(6)
v_mfma_f32_32x32x16_bf16 v[16:31], v[32:35], a[36:39], v[16:31]
ds_read_b64_tr_b16 v[40:41], v4 offset:22528
ds_read_b64_tr_b16 v[42:43], v4 offset:23040
s_waitcnt lgkmcnt(2)
s_waitcnt vmcnt(5)
v_mfma_f32_32x32x16_bf16 v[16:31], v[36:39], a[40:43], v[16:31]
ds_read_b64_tr_b16 v[32:33], v4 offset:24576
ds_read_b64_tr_b16 v[34:35], v4 offset:25088
s_waitcnt lgkmcnt(2)
s_waitcnt vmcnt(4)
v_mfma_f32_32x32x16_bf16 v[16:31], v[40:43], a[44:47], v[16:31]
ds_read_b64_tr_b16 v[36:37], v4 offset:26624
ds_read_b64_tr_b16 v[38:39], v4 offset:27136
s_waitcnt lgkmcnt(2)
s_waitcnt vmcnt(3)
v_mfma_f32_32x32x16_bf16 v[16:31], v[32:35], a[48:51], v[16:31]
ds_read_b64_tr_b16 v[40:41], v4 offset:28672
ds_read_b64_tr_b16 v[42:43], v4 offset:29184
s_waitcnt lgkmcnt(2)
s_waitcnt vmcnt(2)
v_mfma_f32_32x32x16_bf16 v[16:31], v[36:39], a[52:55], v[16:31]
ds_read_b64_tr_b16 v[32:33], v4 offset:30720
ds_read_b64_tr_b16 v[34:35], v4 offset:31232
s_waitcnt lgkmcnt(2)
s_waitcnt vmcnt(1)
v_mfma_f32_32x32x16_bf16 v[16:31], v[40:43], a[56:59], v[16:31]
s_waitcnt lgkmcnt(0)
s_waitcnt vmcnt(0)
v_mfma_f32_32x32x16_bf16 v[16:31], v[32:35], a[60:63], v[16:31]
s_and_b32 s61, s52, 1
s_lshl_b32 s61, s61, 14
s_lshl_b32 s66, s58, 13
s_add_u32 s61, s61, s66
s_add_u32 s61, s61, 0
s_lshl_b32 s66, s67, 11
s_add_u32 s66, s66, s61
v_add_u32 v12, s66, v11
s_lshl_b32 s66, s67, 12
s_add_u32 s66, s66, s61
v_add_u32 v13, s66, v11
s_nop 0
ds_write_b128 v12, v[16:19] offset:0
ds_write_b128 v12, v[20:23] offset:1024
ds_write_b128 v12, v[24:27] offset:4096
ds_write_b128 v12, v[28:31] offset:5120
s_waitcnt lgkmcnt(0)
s_barrier
s_cmp_lt_u32 s52, 4
s_cbranch_scc1 Lgh_51
s_add_u32 s86, s85, 229376
s_add_u32 m0, s76, 98304
s_nop 0
buffer_load_dwordx4 v144, s[72:75], s86 offen lds
s_add_u32 s86, s85, 229376
s_add_u32 m0, s76, 99328
s_nop 0
buffer_load_dwordx4 v145, s[72:75], s86 offen lds
s_add_u32 s86, s85, 229376
s_add_u32 m0, s76, 100352
s_nop 0
buffer_load_dwordx4 v146, s[72:75], s86 offen lds
s_add_u32 s86, s85, 229376
s_add_u32 m0, s76, 101376
s_nop 0
buffer_load_dwordx4 v147, s[72:75], s86 offen lds
s_add_u32 s86, s85, 229376
s_add_u32 m0, s76, 102400
s_nop 0
buffer_load_dwordx4 v148, s[72:75], s86 offen lds
s_add_u32 s86, s85, 229376
s_add_u32 m0, s76, 103424
s_nop 0
buffer_load_dwordx4 v149, s[72:75], s86 offen lds
s_add_u32 s86, s85, 229376
s_add_u32 m0, s76, 104448
s_nop 0
buffer_load_dwordx4 v150, s[72:75], s86 offen lds
s_add_u32 s86, s85, 458752
s_add_u32 m0, s76, 127104
s_nop 0
buffer_load_dwordx4 v144, s[72:75], s86 offen lds
s_add_u32 s86, s85, 458752
s_add_u32 m0, s76, 128128
s_nop 0
buffer_load_dwordx4 v145, s[72:75], s86 offen lds
s_add_u32 s86, s85, 458752
s_add_u32 m0, s76, 129152
s_nop 0
buffer_load_dwordx4 v146, s[72:75], s86 offen lds
s_add_u32 s86, s85, 458752
s_add_u32 m0, s76, 130176
s_nop 0
buffer_load_dwordx4 v147, s[72:75], s86 offen lds
s_add_u32 s86, s85, 458752
s_add_u32 m0, s76, 131200
s_nop 0
buffer_load_dwordx4 v148, s[72:75], s86 offen lds
s_add_u32 s86, s85, 458752
s_add_u32 m0, s76, 132224
s_nop 0
buffer_load_dwordx4 v149, s[72:75], s86 offen lds
s_add_u32 s86, s85, 458752
s_add_u32 m0, s76, 133248
s_nop 0
buffer_load_dwordx4 v150, s[72:75], s86 offen lds
Lgh_51:
ds_read_b128 v[16:19], v13 offset:0
ds_read_b128 v[20:23], v13 offset:1024
ds_read_b128 v[24:27], v13 offset:2048
ds_read_b128 v[28:31], v13 offset:3072
v_lshrrev_b32 v13, 5, v1
v_lshlrev_b32 v13, 5, v13
s_lshl_b32 s65, s65, 6
s_add_u32 s65, s65, 32768
v_add_u32 v13, s65, v13
ds_read_b128 v[56:59], v13
ds_read_b128 v[60:63], v13 offset:16
ds_read_b128 v[64:67], v13 offset:256
ds_read_b128 v[68:71], v13 offset:272
ds_read_b128 v[72:75], v13 offset:512
ds_read_b128 v[76:79], v13 offset:528
ds_read_b128 a[88:91], v13 offset:768
ds_read_b128 a[92:95], v13 offset:784
v_lshlrev_b32 v96, 16, v124
v_and_b32 v97, 0xffff0000, v124
v_lshlrev_b32 v98, 16, v125
v_and_b32 v99, 0xffff0000, v125
v_lshlrev_b32 v100, 16, v126
v_and_b32 v101, 0xffff0000, v126
v_lshlrev_b32 v102, 16, v127
v_and_b32 v103, 0xffff0000, v127
s_waitcnt lgkmcnt(6)
v_add_f32 v16, v16, v24
v_add_f32 v17, v17, v25
v_add_f32 v18, v18, v26
v_add_f32 v19, v19, v27
v_add_f32 v20, v20, v28
v_add_f32 v21, v21, v29
v_add_f32 v22, v22, v30
v_add_f32 v23, v23, v31
v_fmac_f32 v96, v56, v16
v_fmac_f32 v97, v57, v17
v_fmac_f32 v98, v58, v18
v_fmac_f32 v99, v59, v19
v_fmac_f32 v100, v60, v20
v_fmac_f32 v101, v61, v21
v_fmac_f32 v102, v62, v22
v_fmac_f32 v103, v63, v23
v_cvt_pk_bf16_f32 v132, v96, v97
v_cvt_pk_bf16_f32 v133, v98, v99
v_cvt_pk_bf16_f32 v134, v100, v101
v_cvt_pk_bf16_f32 v135, v102, v103
v_lshlrev_b32 v96, 16, v132
v_and_b32 v97, 0xffff0000, v132
v_lshlrev_b32 v98, 16, v133
v_and_b32 v99, 0xffff0000, v133
v_lshlrev_b32 v100, 16, v134
v_and_b32 v101, 0xffff0000, v134
v_lshlrev_b32 v102, 16, v135
v_and_b32 v103, 0xffff0000, v135
v_add_f32 v16, v96, v97
v_mul_f32 v17, v96, v96
v_add_f32 v16, v16, v98
v_add_f32 v16, v16, v99
v_add_f32 v16, v16, v100
v_add_f32 v16, v16, v101
v_add_f32 v16, v16, v102
v_add_f32 v16, v16, v103
v_fmac_f32 v17, v97, v97
v_fmac_f32 v17, v98, v98
v_fmac_f32 v17, v99, v99
v_fmac_f32 v17, v100, v100
v_fmac_f32 v17, v101, v101
v_fmac_f32 v17, v102, v102
v_fmac_f32 v17, v103, v103
v_mov_b32 v20, v16
v_mov_b32 v21, v17
s_nop 0
v_permlane32_swap_b32 v16, v20
v_permlane32_swap_b32 v17, v21
v_add_f32 v16, v16, v20
v_add_f32 v17, v17, v21
v_and_b32 v12, 31, v1
v_lshlrev_b32 v12, 5, v12
s_and_b32 s61, s52, 1
s_lshl_b32 s61, s61, 10
s_add_u32 s61, s61, 33792
v_add_u32 v12, s61, v12
s_lshr_b32 s65, s52, 1
s_lshl_b32 s65, s65, 3
v_add_u32 v13, s65, v12
ds_write_b64 v13, v[16:17]
s_waitcnt lgkmcnt(0)
s_barrier
s_cmp_ge_u32 s52, 2
s_cbranch_scc1 Lp3j_52
ds_read_b128 v[20:23], v12
ds_read_b128 v[24:27], v12 offset:16
v_mov_b32 v18, s53
v_mov_b32 v19, s53
v_and_b32 v13, 31, v1
v_lshlrev_b32 v13, 7, v13
s_lshl_b32 s65, s88, 12
s_add_u32 s65, s65, 9437184
s_and_b32 s66, s51, 7
s_lshl_b32 s66, s66, 4
s_add_u32 s66, s66, s65
v_lshrrev_b32 v2, 5, v1
v_lshl_add_u32 v2, v2, 6, v13
s_waitcnt lgkmcnt(0)
v_add_f32 v16, v20, v22
v_add_f32 v17, v21, v23
v_add_f32 v24, v24, v26
v_add_f32 v25, v25, v27
v_add_f32 v16, v16, v24
v_add_f32 v17, v17, v25
s_cmp_eq_u32 s55, 0
s_cbranch_scc1 Ssl_53
s_mov_b32 exec_hi, 0
buffer_store_dwordx4 v[16:19], v13, s[44:47], s66 offen
s_mov_b64 exec, -1
s_branch Sen_54
Ssl_53:
s_mov_b32 exec_hi, 0
buffer_store_dwordx4 v[16:19], v13, s[44:47], s66 offen sc1
s_mov_b64 exec, -1
Sen_54:
s_mov_b32 s71, 0
SG_55:
buffer_load_dwordx4 v[20:23], v2, s[44:47], s65 offen offset:0 sc1
buffer_load_dwordx4 v[24:27], v2, s[44:47], s65 offen offset:16 sc1
buffer_load_dwordx4 v[28:31], v2, s[44:47], s65 offen offset:32 sc1
buffer_load_dwordx4 v[32:35], v2, s[44:47], s65 offen offset:48 sc1
s_add_u32 s71, s71, 1
s_cmp_gt_u32 s71, 400000
s_cbranch_scc1 SGo_56
s_waitcnt vmcnt(0)
v_xor_b32 v36, s53, v22
v_xor_b32 v37, s53, v26
v_or_b32 v36, v36, v37
v_xor_b32 v37, s53, v30
v_or_b32 v36, v36, v37
v_xor_b32 v37, s53, v34
v_or_b32 v36, v36, v37
v_cmp_ne_u32 vcc, 0, v36
s_nop 0
s_cbranch_vccnz SG_55
SGo_56:
s_waitcnt vmcnt(0)
v_add_f32 v16, v20, v24
v_add_f32 v17, v21, v25
v_add_f32 v28, v28, v32
v_add_f32 v29, v29, v33
v_add_f32 v16, v16, v28
v_add_f32 v17, v17, v29
v_mov_b32 v20, v16
v_mov_b32 v21, v17
s_nop 0
v_permlane32_swap_b32 v16, v20
v_permlane32_swap_b32 v17, v21
v_add_f32 v16, v16, v20
v_add_f32 v17, v17, v21
v_mul_f32 v16, 0x3b000000, v16
v_mul_f32 v17, 0x3b000000, v17
v_fma_f32 v17, -v16, v16, v17
v_max_f32 v17, 0, v17
v_add_f32 v17, 0x3727c5ac, v17
v_rsq_f32 v18, v17
s_nop 0
v_mul_f32 v19, v16, v18
v_sub_f32 v19, 0, v19
ds_write_b64 v12, v[18:19] offset:2048
s_waitcnt lgkmcnt(0)
Lp3j_52:
s_lshl_b32 s65, s88, 15
s_and_b32 s66, s51, 7
s_lshl_b32 s66, s66, 12
s_add_u32 s65, s65, s66
s_lshr_b32 s66, s52, 1
s_lshl_b32 s66, s66, 10
s_add_u32 s65, s65, s66
s_add_u32 s65, s65, 7340032
s_lshl_b32 s66, s56, 5
s_lshl_b32 s67, s52, 2
s_add_u32 s66, s66, s67
s_add_u32 s66, s66, 155648
v_mov_b32 v14, s53
v_mov_b32 v15, 0
s_barrier
ds_read_b64 v[18:19], v12 offset:2048
s_waitcnt lgkmcnt(0)
v_fma_f32 v96, v96, v18, v19
v_fma_f32 v97, v97, v18, v19
v_fma_f32 v98, v98, v18, v19
v_fma_f32 v99, v99, v18, v19
v_fma_f32 v100, v100, v18, v19
v_fma_f32 v101, v101, v18, v19
v_fma_f32 v102, v102, v18, v19
v_fma_f32 v103, v103, v18, v19
v_cvt_pk_bf16_f32 v32, v96, v97
v_cvt_pk_bf16_f32 v33, v98, v99
v_cvt_pk_bf16_f32 v34, v100, v101
v_cvt_pk_bf16_f32 v35, v102, v103
v_lshlrev_b32 v96, 16, v32
v_and_b32 v97, 0xffff0000, v32
v_lshlrev_b32 v98, 16, v33
v_and_b32 v99, 0xffff0000, v33
v_lshlrev_b32 v100, 16, v34
v_and_b32 v101, 0xffff0000, v34
v_lshlrev_b32 v102, 16, v35
v_and_b32 v103, 0xffff0000, v35
v_fma_f32 v96, v96, v72, v64
v_fma_f32 v97, v97, v73, v65
v_fma_f32 v98, v98, v74, v66
v_fma_f32 v99, v99, v75, v67
v_fma_f32 v100, v100, v76, v68
v_fma_f32 v101, v101, v77, v69
v_fma_f32 v102, v102, v78, v70
v_fma_f32 v103, v103, v79, v71
v_cvt_pk_bf16_f32 v32, v96, v97
v_cvt_pk_bf16_f32 v33, v98, v99
v_cvt_pk_bf16_f32 v34, v100, v101
v_cvt_pk_bf16_f32 v35, v102, v103
buffer_store_dwordx4 v[32:35], v11, s[44:47], s65 offen sc1
s_cmp_eq_u32 s55, 0
s_cbranch_scc1 Ssl_57
s_waitcnt vmcnt(0)
s_mov_b64 exec, 1
buffer_store_dword v14, v15, s[44:47], s66 offen
s_mov_b64 exec, -1
s_branch Sen_58
Ssl_57:
s_waitcnt vmcnt(0)
s_mov_b64 exec, 1
buffer_store_dword v14, v15, s[44:47], s66 offen sc1
s_mov_b64 exec, -1
Sen_58:
v_lshrrev_b32 v12, 3, v1
v_mul_u32_u24 v12, 1024, v12
v_and_b32 v2, 7, v1
v_bfe_u32 v13, v1, 4, 1
v_lshlrev_b32 v13, 2, v13
v_xor_b32 v2, v2, v13
v_lshl_add_u32 v12, v2, 4, v12
v_mov_b32 v152, v12
s_and_b32 s81, s51, 7
s_lshl_b32 s81, s81, 7
s_lshl_b32 s83, s52, 13
s_add_u32 s81, s81, s83
s_lshl_b32 s82, s52, 10
s_lshl_b32 s60, s50, 9
s_lshr_b32 s61, s57, 1
s_lshl_b32 s61, s61, 8
s_add_u32 s60, s60, s61
s_and_b32 s61, s57, 1
s_lshl_b32 s61, s61, 2
s_add_u32 s60, s60, s61
s_add_u32 s60, s60, 155648
v_and_b32 v14, 7, v1
v_lshlrev_b32 v14, 5, v14
v_bfe_u32 v15, v1, 3, 2
v_lshl_add_u32 v14, v15, 3, v14
s_lshl_b32 s62, s50, 2
s_add_u32 s62, s62, s57
s_lshl_b32 s62, s62, 15
s_add_u32 s62, s62, 7340032
v_lshrrev_b32 v8, 5, v1
v_bfe_u32 v9, v1, 2, 2
v_lshl_add_u32 v9, v8, 3, v9
v_mul_u32_u24 v7, 224, v9
v_bfe_u32 v9, v1, 4, 1
v_mul_u32_u24 v9, 14464, v9
v_add_u32 v7, v7, v9
v_and_b32 v9, 1, v1
v_lshl_add_u32 v7, v9, 4, v7
v_bfe_u32 v9, v1, 1, 1
v_lshl_add_u32 v7, v9, 3, v7
v_add_u32 v4, 57344, v7
v_add_u32 v5, 98304, v7
v_add_u32 v6, 127104, v7
s_barrier
s_cmp_ge_u32 s52, 4
s_cbranch_scc1 Lgu3_59
ds_read_b64_tr_b16 a[0:1], v4 offset:0
ds_read_b64_tr_b16 a[2:3], v4 offset:896
ds_read_b64_tr_b16 a[4:5], v4 offset:32
ds_read_b64_tr_b16 a[6:7], v4 offset:928
ds_read_b64_tr_b16 a[8:9], v4 offset:64
ds_read_b64_tr_b16 a[10:11], v4 offset:960
ds_read_b64_tr_b16 a[12:13], v4 offset:96
ds_read_b64_tr_b16 a[14:15], v4 offset:992
ds_read_b64_tr_b16 a[16:17], v4 offset:128
ds_read_b64_tr_b16 a[18:19], v4 offset:1024
ds_read_b64_tr_b16 a[20:21], v4 offset:160
ds_read_b64_tr_b16 a[22:23], v4 offset:1056
ds_read_b64_tr_b16 a[24:25], v4 offset:192
ds_read_b64_tr_b16 a[26:27], v4 offset:1088
s_mov_b32 s71, 0
P_61:
buffer_load_dword v15, v14, s[44:47], s60 offen sc1
s_add_u32 s71, s71, 1
s_cmp_gt_u32 s71, 400000
s_cbranch_scc1 Po_62
s_waitcnt vmcnt(0)
v_cmp_ne_u32 vcc, s53, v15
s_nop 0
s_cbranch_vccz Po_62
s_sleep 2
s_branch P_61
Po_62:
s_waitcnt vmcnt(0)
buffer_load_dwordx4 a[56:59], v11, s[44:47], s62 offen offset:0 sc1
buffer_load_dwordx4 a[60:63], v11, s[44:47], s62 offen offset:2048 sc1
s_add_u32 s62, s62, 4096
buffer_load_dwordx4 a[64:67], v11, s[44:47], s62 offen offset:0 sc1
buffer_load_dwordx4 a[68:71], v11, s[44:47], s62 offen offset:2048 sc1
s_add_u32 s62, s62, 4096
buffer_load_dwordx4 a[72:75], v11, s[44:47], s62 offen offset:0 sc1
buffer_load_dwordx4 a[76:79], v11, s[44:47], s62 offen offset:2048 sc1
s_waitcnt lgkmcnt(0)
s_waitcnt vmcnt(5)
v_mfma_f32_32x32x16_bf16 v[16:31], a[0:3], a[56:59], 0
ds_read_b64_tr_b16 a[28:29], v4 offset:7168
ds_read_b64_tr_b16 a[30:31], v4 offset:8064
v_mfma_f32_32x32x16_bf16 v[32:47], a[4:7], a[56:59], 0
s_add_u32 s62, s62, 4096
buffer_load_dwordx4 a[80:83], v11, s[44:47], s62 offen offset:0 sc1
ds_read_b64_tr_b16 a[32:33], v4 offset:7200
ds_read_b64_tr_b16 a[34:35], v4 offset:8096
v_mfma_f32_32x32x16_bf16 v[48:63], a[8:11], a[56:59], 0
ds_read_b64_tr_b16 a[36:37], v4 offset:7232
ds_read_b64_tr_b16 a[38:39], v4 offset:8128
v_mfma_f32_32x32x16_bf16 v[64:79], a[12:15], a[56:59], 0
s_add_u32 s86, s85, 688128
s_add_u32 m0, s76, 0
s_nop 0
buffer_load_dwordx4 v144, s[72:75], s86 offen lds
ds_read_b64_tr_b16 a[40:41], v4 offset:7264
ds_read_b64_tr_b16 a[42:43], v4 offset:8160
v_mfma_f32_32x32x16_bf16 v[80:95], a[16:19], a[56:59], 0
ds_read_b64_tr_b16 a[44:45], v4 offset:7296
ds_read_b64_tr_b16 a[46:47], v4 offset:8192
v_mfma_f32_32x32x16_bf16 v[96:111], a[20:23], a[56:59], 0
s_add_u32 s86, s85, 688128
s_add_u32 m0, s76, 1024
s_nop 0
buffer_load_dwordx4 v145, s[72:75], s86 offen lds
ds_read_b64_tr_b16 a[48:49], v4 offset:7328
ds_read_b64_tr_b16 a[50:51], v4 offset:8224
v_mfma_f32_32x32x16_bf16 v[112:127], a[24:27], a[56:59], 0
s_add_u32 s86, s85, 688128
s_add_u32 m0, s76, 2048
s_nop 0
buffer_load_dwordx4 v146, s[72:75], s86 offen lds
ds_read_b64_tr_b16 a[52:53], v4 offset:7360
ds_read_b64_tr_b16 a[54:55], v4 offset:8256
s_waitcnt lgkmcnt(0)
s_waitcnt vmcnt(4)
s_barrier
s_waitcnt vmcnt(8)
v_mfma_f32_32x32x16_bf16 v[16:31], a[28:31], a[60:63], v[16:31]
ds_read_b64_tr_b16 a[0:1], v5 offset:0
ds_read_b64_tr_b16 a[2:3], v5 offset:896
v_mfma_f32_32x32x16_bf16 v[32:47], a[32:35], a[60:63], v[32:47]
buffer_load_dwordx4 a[84:87], v11, s[44:47], s62 offen offset:2048 sc1
ds_read_b64_tr_b16 a[4:5], v5 offset:32
ds_read_b64_tr_b16 a[6:7], v5 offset:928
v_mfma_f32_32x32x16_bf16 v[48:63], a[36:39], a[60:63], v[48:63]
ds_read_b64_tr_b16 a[8:9], v5 offset:64
ds_read_b64_tr_b16 a[10:11], v5 offset:960
v_mfma_f32_32x32x16_bf16 v[64:79], a[40:43], a[60:63], v[64:79]
s_add_u32 s86, s85, 688128
s_add_u32 m0, s76, 3072
s_nop 0
buffer_load_dwordx4 v147, s[72:75], s86 offen lds
ds_read_b64_tr_b16 a[12:13], v5 offset:96
ds_read_b64_tr_b16 a[14:15], v5 offset:992
v_mfma_f32_32x32x16_bf16 v[80:95], a[44:47], a[60:63], v[80:95]
ds_read_b64_tr_b16 a[16:17], v5 offset:128
ds_read_b64_tr_b16 a[18:19], v5 offset:1024
v_mfma_f32_32x32x16_bf16 v[96:111], a[48:51], a[60:63], v[96:111]
s_add_u32 s86, s85, 688128
s_add_u32 m0, s76, 4096
s_nop 0
buffer_load_dwordx4 v148, s[72:75], s86 offen lds
ds_read_b64_tr_b16 a[20:21], v5 offset:160
ds_read_b64_tr_b16 a[22:23], v5 offset:1056
v_mfma_f32_32x32x16_bf16 v[112:127], a[52:55], a[60:63], v[112:127]
s_add_u32 s86, s85, 688128
s_add_u32 m0, s76, 5120
s_nop 0
buffer_load_dwordx4 v149, s[72:75], s86 offen lds
ds_read_b64_tr_b16 a[24:25], v5 offset:192
ds_read_b64_tr_b16 a[26:27], v5 offset:1088
s_waitcnt lgkmcnt(0)
s_waitcnt vmcnt(11)
v_mfma_f32_32x32x16_bf16 v[16:31], a[0:3], a[64:67], v[16:31]
ds_read_b64_tr_b16 a[28:29], v5 offset:7168
ds_read_b64_tr_b16 a[30:31], v5 offset:8064
v_mfma_f32_32x32x16_bf16 v[32:47], a[4:7], a[64:67], v[32:47]
s_add_u32 s62, s62, 4096
buffer_load_dwordx4 a[56:59], v11, s[44:47], s62 offen offset:0 sc1
ds_read_b64_tr_b16 a[32:33], v5 offset:7200
ds_read_b64_tr_b16 a[34:35], v5 offset:8096
v_mfma_f32_32x32x16_bf16 v[48:63], a[8:11], a[64:67], v[48:63]
ds_read_b64_tr_b16 a[36:37], v5 offset:7232
ds_read_b64_tr_b16 a[38:39], v5 offset:8128
v_mfma_f32_32x32x16_bf16 v[64:79], a[12:15], a[64:67], v[64:79]
s_add_u32 s86, s85, 688128
s_add_u32 m0, s76, 6144
s_nop 0
buffer_load_dwordx4 v150, s[72:75], s86 offen lds
ds_read_b64_tr_b16 a[40:41], v5 offset:7264
ds_read_b64_tr_b16 a[42:43], v5 offset:8160
v_mfma_f32_32x32x16_bf16 v[80:95], a[16:19], a[64:67], v[80:95]
ds_read_b64_tr_b16 a[44:45], v5 offset:7296
ds_read_b64_tr_b16 a[46:47], v5 offset:8192
v_mfma_f32_32x32x16_bf16 v[96:111], a[20:23], a[64:67], v[96:111]
ds_read_b64_tr_b16 a[48:49], v5 offset:7328
ds_read_b64_tr_b16 a[50:51], v5 offset:8224
v_mfma_f32_32x32x16_bf16 v[112:127], a[24:27], a[64:67], v[112:127]
ds_read_b64_tr_b16 a[52:53], v5 offset:7360
ds_read_b64_tr_b16 a[54:55], v5 offset:8256
s_waitcnt lgkmcnt(0)
s_barrier
s_waitcnt vmcnt(12)
v_mfma_f32_32x32x16_bf16 v[16:31], a[28:31], a[68:71], v[16:31]
ds_read_b64_tr_b16 a[0:1], v6 offset:0
ds_read_b64_tr_b16 a[2:3], v6 offset:896
v_mfma_f32_32x32x16_bf16 v[32:47], a[32:35], a[68:71], v[32:47]
buffer_load_dwordx4 a[60:63], v11, s[44:47], s62 offen offset:2048 sc1
ds_read_b64_tr_b16 a[4:5], v6 offset:32
ds_read_b64_tr_b16 a[6:7], v6 offset:928
v_mfma_f32_32x32x16_bf16 v[48:63], a[36:39], a[68:71], v[48:63]
ds_read_b64_tr_b16 a[8:9], v6 offset:64
ds_read_b64_tr_b16 a[10:11], v6 offset:960
v_mfma_f32_32x32x16_bf16 v[64:79], a[40:43], a[68:71], v[64:79]
s_add_u32 s86, s85, 1146880
s_add_u32 m0, s76, 98304
s_nop 0
buffer_load_dwordx4 v144, s[72:75], s86 offen lds
ds_read_b64_tr_b16 a[12:13], v6 offset:96
ds_read_b64_tr_b16 a[14:15], v6 offset:992
v_mfma_f32_32x32x16_bf16 v[80:95], a[44:47], a[68:71], v[80:95]
ds_read_b64_tr_b16 a[16:17], v6 offset:128
ds_read_b64_tr_b16 a[18:19], v6 offset:1024
v_mfma_f32_32x32x16_bf16 v[96:111], a[48:51], a[68:71], v[96:111]
s_add_u32 s86, s85, 1146880
s_add_u32 m0, s76, 99328
s_nop 0
buffer_load_dwordx4 v145, s[72:75], s86 offen lds
ds_read_b64_tr_b16 a[20:21], v6 offset:160
ds_read_b64_tr_b16 a[22:23], v6 offset:1056
v_mfma_f32_32x32x16_bf16 v[112:127], a[52:55], a[68:71], v[112:127]
s_add_u32 s86, s85, 1146880
s_add_u32 m0, s76, 100352
s_nop 0
buffer_load_dwordx4 v146, s[72:75], s86 offen lds
ds_read_b64_tr_b16 a[24:25], v6 offset:192
ds_read_b64_tr_b16 a[26:27], v6 offset:1088
s_waitcnt lgkmcnt(0)
s_waitcnt vmcnt(15)
v_mfma_f32_32x32x16_bf16 v[16:31], a[0:3], a[72:75], v[16:31]
ds_read_b64_tr_b16 a[28:29], v6 offset:7168
ds_read_b64_tr_b16 a[30:31], v6 offset:8064
v_mfma_f32_32x32x16_bf16 v[32:47], a[4:7], a[72:75], v[32:47]
s_add_u32 s62, s62, 4096
buffer_load_dwordx4 a[64:67], v11, s[44:47], s62 offen offset:0 sc1
ds_read_b64_tr_b16 a[32:33], v6 offset:7200
ds_read_b64_tr_b16 a[34:35], v6 offset:8096
v_mfma_f32_32x32x16_bf16 v[48:63], a[8:11], a[72:75], v[48:63]
ds_read_b64_tr_b16 a[36:37], v6 offset:7232
ds_read_b64_tr_b16 a[38:39], v6 offset:8128
v_mfma_f32_32x32x16_bf16 v[64:79], a[12:15], a[72:75], v[64:79]
s_add_u32 s86, s85, 1146880
s_add_u32 m0, s76, 101376
s_nop 0
buffer_load_dwordx4 v147, s[72:75], s86 offen lds
ds_read_b64_tr_b16 a[40:41], v6 offset:7264
ds_read_b64_tr_b16 a[42:43], v6 offset:8160
v_mfma_f32_32x32x16_bf16 v[80:95], a[16:19], a[72:75], v[80:95]
ds_read_b64_tr_b16 a[44:45], v6 offset:7296
ds_read_b64_tr_b16 a[46:47], v6 offset:8192
v_mfma_f32_32x32x16_bf16 v[96:111], a[20:23], a[72:75], v[96:111]
s_add_u32 s86, s85, 1146880
s_add_u32 m0, s76, 102400
s_nop 0
buffer_load_dwordx4 v148, s[72:75], s86 offen lds
ds_read_b64_tr_b16 a[48:49], v6 offset:7328
ds_read_b64_tr_b16 a[50:51], v6 offset:8224
v_mfma_f32_32x32x16_bf16 v[112:127], a[24:27], a[72:75], v[112:127]
s_add_u32 s86, s85, 1146880
s_add_u32 m0, s76, 103424
s_nop 0
buffer_load_dwordx4 v149, s[72:75], s86 offen lds
ds_read_b64_tr_b16 a[52:53], v6 offset:7360
ds_read_b64_tr_b16 a[54:55], v6 offset:8256
s_waitcnt lgkmcnt(0)
s_waitcnt vmcnt(8)
s_barrier
s_waitcnt vmcnt(18)
v_mfma_f32_32x32x16_bf16 v[16:31], a[28:31], a[76:79], v[16:31]
ds_read_b64_tr_b16 a[0:1], v7 offset:0
ds_read_b64_tr_b16 a[2:3], v7 offset:896
v_mfma_f32_32x32x16_bf16 v[32:47], a[32:35], a[76:79], v[32:47]
buffer_load_dwordx4 a[68:71], v11, s[44:47], s62 offen offset:2048 sc1
ds_read_b64_tr_b16 a[4:5], v7 offset:32
ds_read_b64_tr_b16 a[6:7], v7 offset:928
v_mfma_f32_32x32x16_bf16 v[48:63], a[36:39], a[76:79], v[48:63]
ds_read_b64_tr_b16 a[8:9], v7 offset:64
ds_read_b64_tr_b16 a[10:11], v7 offset:960
v_mfma_f32_32x32x16_bf16 v[64:79], a[40:43], a[76:79], v[64:79]
s_add_u32 s86, s85, 1146880
s_add_u32 m0, s76, 104448
s_nop 0
buffer_load_dwordx4 v150, s[72:75], s86 offen lds
ds_read_b64_tr_b16 a[12:13], v7 offset:96
ds_read_b64_tr_b16 a[14:15], v7 offset:992
v_mfma_f32_32x32x16_bf16 v[80:95], a[44:47], a[76:79], v[80:95]
ds_read_b64_tr_b16 a[16:17], v7 offset:128
ds_read_b64_tr_b16 a[18:19], v7 offset:1024
v_mfma_f32_32x32x16_bf16 v[96:111], a[48:51], a[76:79], v[96:111]
ds_read_b64_tr_b16 a[20:21], v7 offset:160
ds_read_b64_tr_b16 a[22:23], v7 offset:1056
v_mfma_f32_32x32x16_bf16 v[112:127], a[52:55], a[76:79], v[112:127]
ds_read_b64_tr_b16 a[24:25], v7 offset:192
ds_read_b64_tr_b16 a[26:27], v7 offset:1088
s_waitcnt lgkmcnt(0)
s_waitcnt vmcnt(19)
v_mfma_f32_32x32x16_bf16 v[16:31], a[0:3], a[80:83], v[16:31]
ds_read_b64_tr_b16 a[28:29], v7 offset:7168
ds_read_b64_tr_b16 a[30:31], v7 offset:8064
v_mfma_f32_32x32x16_bf16 v[32:47], a[4:7], a[80:83], v[32:47]
s_add_u32 s62, s62, 4096
buffer_load_dwordx4 a[72:75], v11, s[44:47], s62 offen offset:0 sc1
ds_read_b64_tr_b16 a[32:33], v7 offset:7200
ds_read_b64_tr_b16 a[34:35], v7 offset:8096
v_mfma_f32_32x32x16_bf16 v[48:63], a[8:11], a[80:83], v[48:63]
ds_read_b64_tr_b16 a[36:37], v7 offset:7232
ds_read_b64_tr_b16 a[38:39], v7 offset:8128
v_mfma_f32_32x32x16_bf16 v[64:79], a[12:15], a[80:83], v[64:79]
ds_read_b64_tr_b16 a[40:41], v7 offset:7264
ds_read_b64_tr_b16 a[42:43], v7 offset:8160
v_mfma_f32_32x32x16_bf16 v[80:95], a[16:19], a[80:83], v[80:95]
ds_read_b64_tr_b16 a[44:45], v7 offset:7296
ds_read_b64_tr_b16 a[46:47], v7 offset:8192
v_mfma_f32_32x32x16_bf16 v[96:111], a[20:23], a[80:83], v[96:111]
ds_read_b64_tr_b16 a[48:49], v7 offset:7328
ds_read_b64_tr_b16 a[50:51], v7 offset:8224
v_mfma_f32_32x32x16_bf16 v[112:127], a[24:27], a[80:83], v[112:127]
ds_read_b64_tr_b16 a[52:53], v7 offset:7360
ds_read_b64_tr_b16 a[54:55], v7 offset:8256
s_waitcnt lgkmcnt(0)
s_barrier
s_waitcnt vmcnt(16)
v_mfma_f32_32x32x16_bf16 v[16:31], a[28:31], a[84:87], v[16:31]
ds_read_b64_tr_b16 a[0:1], v4 offset:0
ds_read_b64_tr_b16 a[2:3], v4 offset:896
v_mfma_f32_32x32x16_bf16 v[32:47], a[32:35], a[84:87], v[32:47]
buffer_load_dwordx4 a[76:79], v11, s[44:47], s62 offen offset:2048 sc1
ds_read_b64_tr_b16 a[4:5], v4 offset:32
ds_read_b64_tr_b16 a[6:7], v4 offset:928
v_mfma_f32_32x32x16_bf16 v[48:63], a[36:39], a[84:87], v[48:63]
ds_read_b64_tr_b16 a[8:9], v4 offset:64
ds_read_b64_tr_b16 a[10:11], v4 offset:960
v_mfma_f32_32x32x16_bf16 v[64:79], a[40:43], a[84:87], v[64:79]
s_add_u32 s86, s85, 1605632
s_add_u32 m0, s76, 0
s_nop 0
buffer_load_dwordx4 v144, s[72:75], s86 offen lds
ds_read_b64_tr_b16 a[12:13], v4 offset:96
ds_read_b64_tr_b16 a[14:15], v4 offset:992
v_mfma_f32_32x32x16_bf16 v[80:95], a[44:47], a[84:87], v[80:95]
ds_read_b64_tr_b16 a[16:17], v4 offset:128
ds_read_b64_tr_b16 a[18:19], v4 offset:1024
v_mfma_f32_32x32x16_bf16 v[96:111], a[48:51], a[84:87], v[96:111]
s_add_u32 s86, s85, 1605632
s_add_u32 m0, s76, 1024
s_nop 0
buffer_load_dwordx4 v145, s[72:75], s86 offen lds
ds_read_b64_tr_b16 a[20:21], v4 offset:160
ds_read_b64_tr_b16 a[22:23], v4 offset:1056
v_mfma_f32_32x32x16_bf16 v[112:127], a[52:55], a[84:87], v[112:127]
s_add_u32 s86, s85, 1605632
s_add_u32 m0, s76, 2048
s_nop 0
buffer_load_dwordx4 v146, s[72:75], s86 offen lds
ds_read_b64_tr_b16 a[24:25], v4 offset:192
ds_read_b64_tr_b16 a[26:27], v4 offset:1088
s_waitcnt lgkmcnt(0)
s_waitcnt vmcnt(16)
v_mfma_f32_32x32x16_bf16 v[16:31], a[0:3], a[56:59], v[16:31]
ds_read_b64_tr_b16 a[28:29], v4 offset:7168
ds_read_b64_tr_b16 a[30:31], v4 offset:8064
v_mfma_f32_32x32x16_bf16 v[32:47], a[4:7], a[56:59], v[32:47]
s_add_u32 s62, s62, 4096
buffer_load_dwordx4 a[80:83], v11, s[44:47], s62 offen offset:0 sc1
ds_read_b64_tr_b16 a[32:33], v4 offset:7200
ds_read_b64_tr_b16 a[34:35], v4 offset:8096
v_mfma_f32_32x32x16_bf16 v[48:63], a[8:11], a[56:59], v[48:63]
ds_read_b64_tr_b16 a[36:37], v4 offset:7232
ds_read_b64_tr_b16 a[38:39], v4 offset:8128
v_mfma_f32_32x32x16_bf16 v[64:79], a[12:15], a[56:59], v[64:79]
s_add_u32 s86, s85, 1605632
s_add_u32 m0, s76, 3072
s_nop 0
buffer_load_dwordx4 v147, s[72:75], s86 offen lds
ds_read_b64_tr_b16 a[40:41], v4 offset:7264
ds_read_b64_tr_b16 a[42:43], v4 offset:8160
v_mfma_f32_32x32x16_bf16 v[80:95], a[16:19], a[56:59], v[80:95]
ds_read_b64_tr_b16 a[44:45], v4 offset:7296
ds_read_b64_tr_b16 a[46:47], v4 offset:8192
v_mfma_f32_32x32x16_bf16 v[96:111], a[20:23], a[56:59], v[96:111]
s_add_u32 s86, s85, 1605632
s_add_u32 m0, s76, 4096
s_nop 0
buffer_load_dwordx4 v148, s[72:75], s86 offen lds
ds_read_b64_tr_b16 a[48:49], v4 offset:7328
ds_read_b64_tr_b16 a[50:51], v4 offset:8224
v_mfma_f32_32x32x16_bf16 v[112:127], a[24:27], a[56:59], v[112:127]
s_add_u32 s86, s85, 1605632
s_add_u32 m0, s76, 5120
s_nop 0
buffer_load_dwordx4 v149, s[72:75], s86 offen lds
ds_read_b64_tr_b16 a[52:53], v4 offset:7360
ds_read_b64_tr_b16 a[54:55], v4 offset:8256
s_waitcnt lgkmcnt(0)
s_waitcnt vmcnt(9)
s_barrier
s_waitcnt vmcnt(18)
v_mfma_f32_32x32x16_bf16 v[16:31], a[28:31], a[60:63], v[16:31]
ds_read_b64_tr_b16 a[0:1], v5 offset:0
ds_read_b64_tr_b16 a[2:3], v5 offset:896
v_mfma_f32_32x32x16_bf16 v[32:47], a[32:35], a[60:63], v[32:47]
buffer_load_dwordx4 a[84:87], v11, s[44:47], s62 offen offset:2048 sc1
ds_read_b64_tr_b16 a[4:5], v5 offset:32
ds_read_b64_tr_b16 a[6:7], v5 offset:928
v_mfma_f32_32x32x16_bf16 v[48:63], a[36:39], a[60:63], v[48:63]
ds_read_b64_tr_b16 a[8:9], v5 offset:64
ds_read_b64_tr_b16 a[10:11], v5 offset:960
v_mfma_f32_32x32x16_bf16 v[64:79], a[40:43], a[60:63], v[64:79]
s_add_u32 s86, s85, 1605632
s_add_u32 m0, s76, 6144
s_nop 0
buffer_load_dwordx4 v150, s[72:75], s86 offen lds
ds_read_b64_tr_b16 a[12:13], v5 offset:96
ds_read_b64_tr_b16 a[14:15], v5 offset:992
v_mfma_f32_32x32x16_bf16 v[80:95], a[44:47], a[60:63], v[80:95]
ds_read_b64_tr_b16 a[16:17], v5 offset:128
ds_read_b64_tr_b16 a[18:19], v5 offset:1024
v_mfma_f32_32x32x16_bf16 v[96:111], a[48:51], a[60:63], v[96:111]
s_mul_i32 s92, s49, 57344
s_lshl_b32 s93, s52, 13
s_add_u32 s92, s92, s93
buffer_load_dword v2, v10, s[28:31], s92 offen
ds_read_b64_tr_b16 a[20:21], v5 offset:160
ds_read_b64_tr_b16 a[22:23], v5 offset:1056
v_mfma_f32_32x32x16_bf16 v[112:127], a[52:55], a[60:63], v[112:127]
ds_read_b64_tr_b16 a[24:25], v5 offset:192
ds_read_b64_tr_b16 a[26:27], v5 offset:1088
s_waitcnt lgkmcnt(0)
s_waitcnt vmcnt(17)
v_mfma_f32_32x32x16_bf16 v[16:31], a[0:3], a[64:67], v[16:31]
ds_read_b64_tr_b16 a[28:29], v5 offset:7168
ds_read_b64_tr_b16 a[30:31], v5 offset:8064
v_mfma_f32_32x32x16_bf16 v[32:47], a[4:7], a[64:67], v[32:47]
ds_read_b64_tr_b16 a[32:33], v5 offset:7200
ds_read_b64_tr_b16 a[34:35], v5 offset:8096
v_mfma_f32_32x32x16_bf16 v[48:63], a[8:11], a[64:67], v[48:63]
ds_read_b64_tr_b16 a[36:37], v5 offset:7232
ds_read_b64_tr_b16 a[38:39], v5 offset:8128
v_mfma_f32_32x32x16_bf16 v[64:79], a[12:15], a[64:67], v[64:79]
ds_read_b64_tr_b16 a[40:41], v5 offset:7264
ds_read_b64_tr_b16 a[42:43], v5 offset:8160
v_mfma_f32_32x32x16_bf16 v[80:95], a[16:19], a[64:67], v[80:95]
ds_read_b64_tr_b16 a[44:45], v5 offset:7296
ds_read_b64_tr_b16 a[46:47], v5 offset:8192
v_mfma_f32_32x32x16_bf16 v[96:111], a[20:23], a[64:67], v[96:111]
ds_read_b64_tr_b16 a[48:49], v5 offset:7328
ds_read_b64_tr_b16 a[50:51], v5 offset:8224
v_mfma_f32_32x32x16_bf16 v[112:127], a[24:27], a[64:67], v[112:127]
ds_read_b64_tr_b16 a[52:53], v5 offset:7360
ds_read_b64_tr_b16 a[54:55], v5 offset:8256
s_waitcnt lgkmcnt(0)
s_barrier
s_waitcnt vmcnt(13)
v_mfma_f32_32x32x16_bf16 v[16:31], a[28:31], a[68:71], v[16:31]
ds_read_b64_tr_b16 a[0:1], v6 offset:0
ds_read_b64_tr_b16 a[2:3], v6 offset:896
v_mfma_f32_32x32x16_bf16 v[32:47], a[32:35], a[68:71], v[32:47]
ds_read_b64_tr_b16 a[4:5], v6 offset:32
ds_read_b64_tr_b16 a[6:7], v6 offset:928
v_mfma_f32_32x32x16_bf16 v[48:63], a[36:39], a[68:71], v[48:63]
ds_read_b64_tr_b16 a[8:9], v6 offset:64
ds_read_b64_tr_b16 a[10:11], v6 offset:960
v_mfma_f32_32x32x16_bf16 v[64:79], a[40:43], a[68:71], v[64:79]
ds_read_b64_tr_b16 a[12:13], v6 offset:96
ds_read_b64_tr_b16 a[14:15], v6 offset:992
v_mfma_f32_32x32x16_bf16 v[80:95], a[44:47], a[68:71], v[80:95]
ds_read_b64_tr_b16 a[16:17], v6 offset:128
ds_read_b64_tr_b16 a[18:19], v6 offset:1024
v_mfma_f32_32x32x16_bf16 v[96:111], a[48:51], a[68:71], v[96:111]
ds_read_b64_tr_b16 a[20:21], v6 offset:160
ds_read_b64_tr_b16 a[22:23], v6 offset:1056
v_mfma_f32_32x32x16_bf16 v[112:127], a[52:55], a[68:71], v[112:127]
ds_read_b64_tr_b16 a[24:25], v6 offset:192
ds_read_b64_tr_b16 a[26:27], v6 offset:1088
s_waitcnt lgkmcnt(0)
s_waitcnt vmcnt(11)
v_mfma_f32_32x32x16_bf16 v[16:31], a[0:3], a[72:75], v[16:31]
ds_read_b64_tr_b16 a[28:29], v6 offset:7168
ds_read_b64_tr_b16 a[30:31], v6 offset:8064
v_mfma_f32_32x32x16_bf16 v[32:47], a[4:7], a[72:75], v[32:47]
ds_read_b64_tr_b16 a[32:33], v6 offset:7200
ds_read_b64_tr_b16 a[34:35], v6 offset:8096
v_mfma_f32_32x32x16_bf16 v[48:63], a[8:11], a[72:75], v[48:63]
ds_read_b64_tr_b16 a[36:37], v6 offset:7232
ds_read_b64_tr_b16 a[38:39], v6 offset:8128
v_mfma_f32_32x32x16_bf16 v[64:79], a[12:15], a[72:75], v[64:79]
ds_read_b64_tr_b16 a[40:41], v6 offset:7264
ds_read_b64_tr_b16 a[42:43], v6 offset:8160
v_mfma_f32_32x32x16_bf16 v[80:95], a[16:19], a[72:75], v[80:95]
ds_read_b64_tr_b16 a[44:45], v6 offset:7296
ds_read_b64_tr_b16 a[46:47], v6 offset:8192
v_mfma_f32_32x32x16_bf16 v[96:111], a[20:23], a[72:75], v[96:111]
ds_read_b64_tr_b16 a[48:49], v6 offset:7328
ds_read_b64_tr_b16 a[50:51], v6 offset:8224
v_mfma_f32_32x32x16_bf16 v[112:127], a[24:27], a[72:75], v[112:127]
ds_read_b64_tr_b16 a[52:53], v6 offset:7360
ds_read_b64_tr_b16 a[54:55], v6 offset:8256
s_waitcnt lgkmcnt(0)
s_waitcnt vmcnt(1)
s_barrier
s_waitcnt vmcnt(10)
v_mfma_f32_32x32x16_bf16 v[16:31], a[28:31], a[76:79], v[16:31]
ds_read_b64_tr_b16 a[0:1], v7 offset:0
ds_read_b64_tr_b16 a[2:3], v7 offset:896
v_mfma_f32_32x32x16_bf16 v[32:47], a[32:35], a[76:79], v[32:47]
s_add_u32 m0, s82, 127104
s_add_u32 s83, s81, 0
buffer_load_dwordx4 v152, s[28:31], s83 offen lds
ds_read_b64_tr_b16 a[4:5], v7 offset:32
ds_read_b64_tr_b16 a[6:7], v7 offset:928
v_mfma_f32_32x32x16_bf16 v[48:63], a[36:39], a[76:79], v[48:63]
ds_read_b64_tr_b16 a[8:9], v7 offset:64
ds_read_b64_tr_b16 a[10:11], v7 offset:960
v_mfma_f32_32x32x16_bf16 v[64:79], a[40:43], a[76:79], v[64:79]
s_add_u32 m0, s82, 135296
s_add_u32 s83, s81, 458752
buffer_load_dwordx4 v152, s[28:31], s83 offen lds
ds_read_b64_tr_b16 a[12:13], v7 offset:96
ds_read_b64_tr_b16 a[14:15], v7 offset:992
v_mfma_f32_32x32x16_bf16 v[80:95], a[44:47], a[76:79], v[80:95]
ds_read_b64_tr_b16 a[16:17], v7 offset:128
ds_read_b64_tr_b16 a[18:19], v7 offset:1024
v_mfma_f32_32x32x16_bf16 v[96:111], a[48:51], a[76:79], v[96:111]
s_add_u32 m0, s82, 143488
s_add_u32 s83, s81, 917504
buffer_load_dwordx4 v152, s[28:31], s83 offen lds
ds_read_b64_tr_b16 a[20:21], v7 offset:160
ds_read_b64_tr_b16 a[22:23], v7 offset:1056
v_mfma_f32_32x32x16_bf16 v[112:127], a[52:55], a[76:79], v[112:127]
ds_read_b64_tr_b16 a[24:25], v7 offset:192
ds_read_b64_tr_b16 a[26:27], v7 offset:1088
s_waitcnt lgkmcnt(0)
s_waitcnt vmcnt(9)
v_mfma_f32_32x32x16_bf16 v[16:31], a[0:3], a[80:83], v[16:31]
ds_read_b64_tr_b16 a[28:29], v7 offset:7168
ds_read_b64_tr_b16 a[30:31], v7 offset:8064
v_mfma_f32_32x32x16_bf16 v[32:47], a[4:7], a[80:83], v[32:47]
s_add_u32 m0, s82, 151680
s_add_u32 s83, s81, 1376256
buffer_load_dwordx4 v152, s[28:31], s83 offen lds
ds_read_b64_tr_b16 a[32:33], v7 offset:7200
ds_read_b64_tr_b16 a[34:35], v7 offset:8096
v_mfma_f32_32x32x16_bf16 v[48:63], a[8:11], a[80:83], v[48:63]
ds_read_b64_tr_b16 a[36:37], v7 offset:7232
ds_read_b64_tr_b16 a[38:39], v7 offset:8128
v_mfma_f32_32x32x16_bf16 v[64:79], a[12:15], a[80:83], v[64:79]
ds_read_b64_tr_b16 a[40:41], v7 offset:7264
ds_read_b64_tr_b16 a[42:43], v7 offset:8160
v_mfma_f32_32x32x16_bf16 v[80:95], a[16:19], a[80:83], v[80:95]
ds_read_b64_tr_b16 a[44:45], v7 offset:7296
ds_read_b64_tr_b16 a[46:47], v7 offset:8192
v_mfma_f32_32x32x16_bf16 v[96:111], a[20:23], a[80:83], v[96:111]
ds_read_b64_tr_b16 a[48:49], v7 offset:7328
ds_read_b64_tr_b16 a[50:51], v7 offset:8224
v_mfma_f32_32x32x16_bf16 v[112:127], a[24:27], a[80:83], v[112:127]
ds_read_b64_tr_b16 a[52:53], v7 offset:7360
ds_read_b64_tr_b16 a[54:55], v7 offset:8256
s_waitcnt lgkmcnt(0)
s_waitcnt vmcnt(6)
v_mfma_f32_32x32x16_bf16 v[16:31], a[28:31], a[84:87], v[16:31]
v_mfma_f32_32x32x16_bf16 v[32:47], a[32:35], a[84:87], v[32:47]
v_mfma_f32_32x32x16_bf16 v[48:63], a[36:39], a[84:87], v[48:63]
v_mfma_f32_32x32x16_bf16 v[64:79], a[40:43], a[84:87], v[64:79]
v_mfma_f32_32x32x16_bf16 v[80:95], a[44:47], a[84:87], v[80:95]
v_mfma_f32_32x32x16_bf16 v[96:111], a[48:51], a[84:87], v[96:111]
v_mfma_f32_32x32x16_bf16 v[112:127], a[52:55], a[84:87], v[112:127]
s_mul_i32 s65, s57, 12288
s_add_u32 s65, s65, 65536
v_add_u32 v12, s65, v11
s_mul_i32 s65, s57, 16384
s_add_u32 s65, s65, 0
v_add_u32 v13, s65, v11
s_barrier
s_nop 2
ds_write_b128 v12, v[80:83] offset:0
ds_write_b128 v12, v[84:87] offset:1024
ds_write_b128 v12, v[88:91] offset:2048
ds_write_b128 v12, v[92:95] offset:3072
ds_write_b128 v12, v[96:99] offset:4096
ds_write_b128 v12, v[100:103] offset:5120
ds_write_b128 v12, v[104:107] offset:6144
ds_write_b128 v12, v[108:111] offset:7168
ds_write_b128 v12, v[112:115] offset:8192
ds_write_b128 v12, v[116:119] offset:9216
ds_write_b128 v12, v[120:123] offset:10240
ds_write_b128 v12, v[124:127] offset:11264
v_mov_b32 v9, 0xbdd2d3e8
v_mov_b32 v8, 0xc0135761
s_lshl_b32 s65, s50, 2
s_add_u32 s65, s65, s57
s_mul_i32 s65, s65, 114688
s_mul_i32 s66, s51, 7168
s_add_u32 s65, s65, s66
s_lshl_b32 s66, s58, 12
s_add_u32 s65, s65, s66
s_add_u32 s65, s65, 10485760
s_lshl_b32 s66, s56, 5
s_lshl_b32 s67, s52, 2
s_add_u32 s66, s66, s67
s_add_u32 s66, s66, 163840
v_mov_b32 v14, s53
v_mov_b32 v15, 0
s_waitcnt lgkmcnt(0)
s_barrier
ds_read_b128 v[80:83], v13 offset:0
ds_read_b128 v[84:87], v13 offset:1024
ds_read_b128 v[88:91], v13 offset:2048
ds_read_b128 v[92:95], v13 offset:3072
ds_read_b128 v[96:99], v13 offset:4096
ds_read_b128 v[100:103], v13 offset:5120
ds_read_b128 v[104:107], v13 offset:6144
ds_read_b128 v[108:111], v13 offset:7168
ds_read_b128 v[112:115], v13 offset:8192
ds_read_b128 v[116:119], v13 offset:9216
ds_read_b128 v[120:123], v13 offset:10240
ds_read_b128 v[124:127], v13 offset:11264
s_waitcnt lgkmcnt(8)
v_pk_add_f32 v[16:17], v[16:17], v[80:81]
v_pk_add_f32 v[18:19], v[18:19], v[82:83]
v_pk_add_f32 v[20:21], v[20:21], v[84:85]
v_pk_add_f32 v[22:23], v[22:23], v[86:87]
v_pk_add_f32 v[24:25], v[24:25], v[88:89]
v_pk_add_f32 v[26:27], v[26:27], v[90:91]
v_pk_add_f32 v[28:29], v[28:29], v[92:93]
v_pk_add_f32 v[30:31], v[30:31], v[94:95]
v_pk_mul_f32 v[80:81], v[16:17], v[16:17]
v_pk_mul_f32 v[82:83], v[18:19], v[18:19]
v_pk_mul_f32 v[84:85], v[20:21], v[20:21]
v_pk_mul_f32 v[86:87], v[22:23], v[22:23]
v_pk_fma_f32 v[80:81], v[80:81], v[8:9], v[8:9] op_sel:[0,1,0] op_sel_hi:[1,1,0]
v_pk_fma_f32 v[82:83], v[82:83], v[8:9], v[8:9] op_sel:[0,1,0] op_sel_hi:[1,1,0]
v_pk_fma_f32 v[84:85], v[84:85], v[8:9], v[8:9] op_sel:[0,1,0] op_sel_hi:[1,1,0]
v_pk_fma_f32 v[86:87], v[86:87], v[8:9], v[8:9] op_sel:[0,1,0] op_sel_hi:[1,1,0]
v_pk_mul_f32 v[80:81], v[80:81], v[16:17]
v_pk_mul_f32 v[82:83], v[82:83], v[18:19]
v_pk_mul_f32 v[84:85], v[84:85], v[20:21]
v_pk_mul_f32 v[86:87], v[86:87], v[22:23]
v_exp_f32 v80, v80
v_exp_f32 v81, v81
v_exp_f32 v82, v82
v_exp_f32 v83, v83
v_exp_f32 v84, v84
v_exp_f32 v85, v85
v_exp_f32 v86, v86
v_exp_f32 v87, v87
v_pk_mul_f32 v[16:17], v[16:17], v[24:25]
v_pk_mul_f32 v[18:19], v[18:19], v[26:27]
v_pk_mul_f32 v[20:21], v[20:21], v[28:29]
v_pk_mul_f32 v[22:23], v[22:23], v[30:31]
v_add_f32 v80, 1.0, v80
v_add_f32 v81, 1.0, v81
v_add_f32 v82, 1.0, v82
v_add_f32 v83, 1.0, v83
v_add_f32 v84, 1.0, v84
v_add_f32 v85, 1.0, v85
v_add_f32 v86, 1.0, v86
v_add_f32 v87, 1.0, v87
v_rcp_f32 v80, v80
v_rcp_f32 v81, v81
v_rcp_f32 v82, v82
v_rcp_f32 v83, v83
v_rcp_f32 v84, v84
v_rcp_f32 v85, v85
v_rcp_f32 v86, v86
v_rcp_f32 v87, v87
v_pk_mul_f32 v[16:17], v[16:17], v[80:81]
v_pk_mul_f32 v[18:19], v[18:19], v[82:83]
v_pk_mul_f32 v[20:21], v[20:21], v[84:85]
v_pk_mul_f32 v[22:23], v[22:23], v[86:87]
v_cvt_pk_bf16_f32 v24, v16, v17
v_cvt_pk_bf16_f32 v25, v18, v19
v_cvt_pk_bf16_f32 v26, v20, v21
v_cvt_pk_bf16_f32 v27, v22, v23
buffer_store_dwordx4 v[24:27], v11, s[44:47], s65 offen offset:0 sc1
s_waitcnt lgkmcnt(4)
v_pk_add_f32 v[32:33], v[32:33], v[96:97]
v_pk_add_f32 v[34:35], v[34:35], v[98:99]
v_pk_add_f32 v[36:37], v[36:37], v[100:101]
v_pk_add_f32 v[38:39], v[38:39], v[102:103]
v_pk_add_f32 v[40:41], v[40:41], v[104:105]
v_pk_add_f32 v[42:43], v[42:43], v[106:107]
v_pk_add_f32 v[44:45], v[44:45], v[108:109]
v_pk_add_f32 v[46:47], v[46:47], v[110:111]
v_pk_mul_f32 v[96:97], v[32:33], v[32:33]
v_pk_mul_f32 v[98:99], v[34:35], v[34:35]
v_pk_mul_f32 v[100:101], v[36:37], v[36:37]
v_pk_mul_f32 v[102:103], v[38:39], v[38:39]
v_pk_fma_f32 v[96:97], v[96:97], v[8:9], v[8:9] op_sel:[0,1,0] op_sel_hi:[1,1,0]
v_pk_fma_f32 v[98:99], v[98:99], v[8:9], v[8:9] op_sel:[0,1,0] op_sel_hi:[1,1,0]
v_pk_fma_f32 v[100:101], v[100:101], v[8:9], v[8:9] op_sel:[0,1,0] op_sel_hi:[1,1,0]
v_pk_fma_f32 v[102:103], v[102:103], v[8:9], v[8:9] op_sel:[0,1,0] op_sel_hi:[1,1,0]
v_pk_mul_f32 v[96:97], v[96:97], v[32:33]
v_pk_mul_f32 v[98:99], v[98:99], v[34:35]
v_pk_mul_f32 v[100:101], v[100:101], v[36:37]
v_pk_mul_f32 v[102:103], v[102:103], v[38:39]
v_exp_f32 v96, v96
v_exp_f32 v97, v97
v_exp_f32 v98, v98
v_exp_f32 v99, v99
v_exp_f32 v100, v100
v_exp_f32 v101, v101
v_exp_f32 v102, v102
v_exp_f32 v103, v103
v_pk_mul_f32 v[32:33], v[32:33], v[40:41]
v_pk_mul_f32 v[34:35], v[34:35], v[42:43]
v_pk_mul_f32 v[36:37], v[36:37], v[44:45]
v_pk_mul_f32 v[38:39], v[38:39], v[46:47]
v_add_f32 v96, 1.0, v96
v_add_f32 v97, 1.0, v97
v_add_f32 v98, 1.0, v98
v_add_f32 v99, 1.0, v99
v_add_f32 v100, 1.0, v100
v_add_f32 v101, 1.0, v101
v_add_f32 v102, 1.0, v102
v_add_f32 v103, 1.0, v103
v_rcp_f32 v96, v96
v_rcp_f32 v97, v97
v_rcp_f32 v98, v98
v_rcp_f32 v99, v99
v_rcp_f32 v100, v100
v_rcp_f32 v101, v101
v_rcp_f32 v102, v102
v_rcp_f32 v103, v103
v_pk_mul_f32 v[32:33], v[32:33], v[96:97]
v_pk_mul_f32 v[34:35], v[34:35], v[98:99]
v_pk_mul_f32 v[36:37], v[36:37], v[100:101]
v_pk_mul_f32 v[38:39], v[38:39], v[102:103]
v_cvt_pk_bf16_f32 v40, v32, v33
v_cvt_pk_bf16_f32 v41, v34, v35
v_cvt_pk_bf16_f32 v42, v36, v37
v_cvt_pk_bf16_f32 v43, v38, v39
buffer_store_dwordx4 v[40:43], v11, s[44:47], s65 offen offset:1024 sc1
s_waitcnt lgkmcnt(0)
v_pk_add_f32 v[48:49], v[48:49], v[112:113]
v_pk_add_f32 v[50:51], v[50:51], v[114:115]
v_pk_add_f32 v[52:53], v[52:53], v[116:117]
v_pk_add_f32 v[54:55], v[54:55], v[118:119]
v_pk_add_f32 v[56:57], v[56:57], v[120:121]
v_pk_add_f32 v[58:59], v[58:59], v[122:123]
v_pk_add_f32 v[60:61], v[60:61], v[124:125]
v_pk_add_f32 v[62:63], v[62:63], v[126:127]
v_pk_mul_f32 v[112:113], v[48:49], v[48:49]
v_pk_mul_f32 v[114:115], v[50:51], v[50:51]
v_pk_mul_f32 v[116:117], v[52:53], v[52:53]
v_pk_mul_f32 v[118:119], v[54:55], v[54:55]
v_pk_fma_f32 v[112:113], v[112:113], v[8:9], v[8:9] op_sel:[0,1,0] op_sel_hi:[1,1,0]
v_pk_fma_f32 v[114:115], v[114:115], v[8:9], v[8:9] op_sel:[0,1,0] op_sel_hi:[1,1,0]
v_pk_fma_f32 v[116:117], v[116:117], v[8:9], v[8:9] op_sel:[0,1,0] op_sel_hi:[1,1,0]
v_pk_fma_f32 v[118:119], v[118:119], v[8:9], v[8:9] op_sel:[0,1,0] op_sel_hi:[1,1,0]
v_pk_mul_f32 v[112:113], v[112:113], v[48:49]
v_pk_mul_f32 v[114:115], v[114:115], v[50:51]
v_pk_mul_f32 v[116:117], v[116:117], v[52:53]
v_pk_mul_f32 v[118:119], v[118:119], v[54:55]
v_exp_f32 v112, v112
v_exp_f32 v113, v113
v_exp_f32 v114, v114
v_exp_f32 v115, v115
v_exp_f32 v116, v116
v_exp_f32 v117, v117
v_exp_f32 v118, v118
v_exp_f32 v119, v119
v_pk_mul_f32 v[48:49], v[48:49], v[56:57]
v_pk_mul_f32 v[50:51], v[50:51], v[58:59]
v_pk_mul_f32 v[52:53], v[52:53], v[60:61]
v_pk_mul_f32 v[54:55], v[54:55], v[62:63]
v_add_f32 v112, 1.0, v112
v_add_f32 v113, 1.0, v113
v_add_f32 v114, 1.0, v114
v_add_f32 v115, 1.0, v115
v_add_f32 v116, 1.0, v116
v_add_f32 v117, 1.0, v117
v_add_f32 v118, 1.0, v118
v_add_f32 v119, 1.0, v119
v_rcp_f32 v112, v112
v_rcp_f32 v113, v113
v_rcp_f32 v114, v114
v_rcp_f32 v115, v115
v_rcp_f32 v116, v116
v_rcp_f32 v117, v117
v_rcp_f32 v118, v118
v_rcp_f32 v119, v119
v_pk_mul_f32 v[48:49], v[48:49], v[112:113]
v_pk_mul_f32 v[50:51], v[50:51], v[114:115]
v_pk_mul_f32 v[52:53], v[52:53], v[116:117]
v_pk_mul_f32 v[54:55], v[54:55], v[118:119]
v_cvt_pk_bf16_f32 v56, v48, v49
v_cvt_pk_bf16_f32 v57, v50, v51
v_cvt_pk_bf16_f32 v58, v52, v53
v_cvt_pk_bf16_f32 v59, v54, v55
buffer_store_dwordx4 v[56:59], v11, s[44:47], s65 offen offset:2048 sc1
ds_read_b128 v[80:83], v13 offset:12288
ds_read_b128 v[84:87], v13 offset:13312
ds_read_b128 v[88:91], v13 offset:14336
ds_read_b128 v[92:95], v13 offset:15360
s_waitcnt lgkmcnt(0)
v_pk_add_f32 v[64:65], v[64:65], v[80:81]
v_pk_add_f32 v[66:67], v[66:67], v[82:83]
v_pk_add_f32 v[68:69], v[68:69], v[84:85]
v_pk_add_f32 v[70:71], v[70:71], v[86:87]
v_pk_add_f32 v[72:73], v[72:73], v[88:89]
v_pk_add_f32 v[74:75], v[74:75], v[90:91]
v_pk_add_f32 v[76:77], v[76:77], v[92:93]
v_pk_add_f32 v[78:79], v[78:79], v[94:95]
v_pk_mul_f32 v[80:81], v[64:65], v[64:65]
v_pk_mul_f32 v[82:83], v[66:67], v[66:67]
v_pk_mul_f32 v[84:85], v[68:69], v[68:69]
v_pk_mul_f32 v[86:87], v[70:71], v[70:71]
v_pk_fma_f32 v[80:81], v[80:81], v[8:9], v[8:9] op_sel:[0,1,0] op_sel_hi:[1,1,0]
v_pk_fma_f32 v[82:83], v[82:83], v[8:9], v[8:9] op_sel:[0,1,0] op_sel_hi:[1,1,0]
v_pk_fma_f32 v[84:85], v[84:85], v[8:9], v[8:9] op_sel:[0,1,0] op_sel_hi:[1,1,0]
v_pk_fma_f32 v[86:87], v[86:87], v[8:9], v[8:9] op_sel:[0,1,0] op_sel_hi:[1,1,0]
v_pk_mul_f32 v[80:81], v[80:81], v[64:65]
v_pk_mul_f32 v[82:83], v[82:83], v[66:67]
v_pk_mul_f32 v[84:85], v[84:85], v[68:69]
v_pk_mul_f32 v[86:87], v[86:87], v[70:71]
v_exp_f32 v80, v80
v_exp_f32 v81, v81
v_exp_f32 v82, v82
v_exp_f32 v83, v83
v_exp_f32 v84, v84
v_exp_f32 v85, v85
v_exp_f32 v86, v86
v_exp_f32 v87, v87
v_pk_mul_f32 v[64:65], v[64:65], v[72:73]
v_pk_mul_f32 v[66:67], v[66:67], v[74:75]
v_pk_mul_f32 v[68:69], v[68:69], v[76:77]
v_pk_mul_f32 v[70:71], v[70:71], v[78:79]
v_add_f32 v80, 1.0, v80
v_add_f32 v81, 1.0, v81
v_add_f32 v82, 1.0, v82
v_add_f32 v83, 1.0, v83
v_add_f32 v84, 1.0, v84
v_add_f32 v85, 1.0, v85
v_add_f32 v86, 1.0, v86
v_add_f32 v87, 1.0, v87
v_rcp_f32 v80, v80
v_rcp_f32 v81, v81
v_rcp_f32 v82, v82
v_rcp_f32 v83, v83
v_rcp_f32 v84, v84
v_rcp_f32 v85, v85
v_rcp_f32 v86, v86
v_rcp_f32 v87, v87
v_pk_mul_f32 v[64:65], v[64:65], v[80:81]
v_pk_mul_f32 v[66:67], v[66:67], v[82:83]
v_pk_mul_f32 v[68:69], v[68:69], v[84:85]
v_pk_mul_f32 v[70:71], v[70:71], v[86:87]
v_cvt_pk_bf16_f32 v72, v64, v65
v_cvt_pk_bf16_f32 v73, v66, v67
v_cvt_pk_bf16_f32 v74, v68, v69
v_cvt_pk_bf16_f32 v75, v70, v71
buffer_store_dwordx4 v[72:75], v11, s[44:47], s65 offen offset:3072 sc1
s_cmp_eq_u32 s55, 0
s_cbranch_scc1 Ssl_63
s_waitcnt vmcnt(0)
s_mov_b64 exec, 1
buffer_store_dword v14, v15, s[44:47], s66 offen
s_mov_b64 exec, -1
s_branch Sen_64
Ssl_63:
s_waitcnt vmcnt(0)
s_mov_b64 exec, 1
buffer_store_dword v14, v15, s[44:47], s66 offen sc1
s_mov_b64 exec, -1
Sen_64:
s_branch Lguj_60
Lgu3_59:
ds_read_b64_tr_b16 a[0:1], v4 offset:3584
ds_read_b64_tr_b16 a[2:3], v4 offset:4480
ds_read_b64_tr_b16 a[4:5], v4 offset:3616
ds_read_b64_tr_b16 a[6:7], v4 offset:4512
ds_read_b64_tr_b16 a[8:9], v4 offset:3648
ds_read_b64_tr_b16 a[10:11], v4 offset:4544
ds_read_b64_tr_b16 a[12:13], v4 offset:3680
ds_read_b64_tr_b16 a[14:15], v4 offset:4576
ds_read_b64_tr_b16 a[16:17], v4 offset:3712
ds_read_b64_tr_b16 a[18:19], v4 offset:4608
ds_read_b64_tr_b16 a[20:21], v4 offset:3744
ds_read_b64_tr_b16 a[22:23], v4 offset:4640
ds_read_b64_tr_b16 a[24:25], v4 offset:3776
ds_read_b64_tr_b16 a[26:27], v4 offset:4672
s_mov_b32 s71, 0
P_65:
buffer_load_dword v15, v14, s[44:47], s60 offen sc1
s_add_u32 s71, s71, 1
s_cmp_gt_u32 s71, 400000
s_cbranch_scc1 Po_66
s_waitcnt vmcnt(0)
v_cmp_ne_u32 vcc, s53, v15
s_nop 0
s_cbranch_vccz Po_66
s_sleep 2
s_branch P_65
Po_66:
s_waitcnt vmcnt(0)
buffer_load_dwordx4 a[56:59], v11, s[44:47], s62 offen offset:1024 sc1
buffer_load_dwordx4 a[60:63], v11, s[44:47], s62 offen offset:3072 sc1
s_add_u32 s62, s62, 4096
buffer_load_dwordx4 a[64:67], v11, s[44:47], s62 offen offset:1024 sc1
buffer_load_dwordx4 a[68:71], v11, s[44:47], s62 offen offset:3072 sc1
s_add_u32 s62, s62, 4096
buffer_load_dwordx4 a[72:75], v11, s[44:47], s62 offen offset:1024 sc1
buffer_load_dwordx4 a[76:79], v11, s[44:47], s62 offen offset:3072 sc1
s_waitcnt lgkmcnt(0)
s_waitcnt vmcnt(5)
v_mfma_f32_32x32x16_bf16 v[16:31], a[0:3], a[56:59], 0
ds_read_b64_tr_b16 a[28:29], v4 offset:10752
ds_read_b64_tr_b16 a[30:31], v4 offset:11648
v_mfma_f32_32x32x16_bf16 v[32:47], a[4:7], a[56:59], 0
s_add_u32 s62, s62, 4096
buffer_load_dwordx4 a[80:83], v11, s[44:47], s62 offen offset:1024 sc1
ds_read_b64_tr_b16 a[32:33], v4 offset:10784
ds_read_b64_tr_b16 a[34:35], v4 offset:11680
v_mfma_f32_32x32x16_bf16 v[48:63], a[8:11], a[56:59], 0
ds_read_b64_tr_b16 a[36:37], v4 offset:10816
ds_read_b64_tr_b16 a[38:39], v4 offset:11712
v_mfma_f32_32x32x16_bf16 v[64:79], a[12:15], a[56:59], 0
ds_read_b64_tr_b16 a[40:41], v4 offset:10848
ds_read_b64_tr_b16 a[42:43], v4 offset:11744
v_mfma_f32_32x32x16_bf16 v[80:95], a[16:19], a[56:59], 0
ds_read_b64_tr_b16 a[44:45], v4 offset:10880
ds_read_b64_tr_b16 a[46:47], v4 offset:11776
v_mfma_f32_32x32x16_bf16 v[96:111], a[20:23], a[56:59], 0
ds_read_b64_tr_b16 a[48:49], v4 offset:10912
ds_read_b64_tr_b16 a[50:51], v4 offset:11808
v_mfma_f32_32x32x16_bf16 v[112:127], a[24:27], a[56:59], 0
ds_read_b64_tr_b16 a[52:53], v4 offset:10944
ds_read_b64_tr_b16 a[54:55], v4 offset:11840
s_waitcnt lgkmcnt(0)
s_barrier
s_waitcnt vmcnt(5)
v_mfma_f32_32x32x16_bf16 v[16:31], a[28:31], a[60:63], v[16:31]
ds_read_b64_tr_b16 a[0:1], v5 offset:3584
ds_read_b64_tr_b16 a[2:3], v5 offset:4480
v_mfma_f32_32x32x16_bf16 v[32:47], a[32:35], a[60:63], v[32:47]
buffer_load_dwordx4 a[84:87], v11, s[44:47], s62 offen offset:3072 sc1
ds_read_b64_tr_b16 a[4:5], v5 offset:3616
ds_read_b64_tr_b16 a[6:7], v5 offset:4512
v_mfma_f32_32x32x16_bf16 v[48:63], a[36:39], a[60:63], v[48:63]
ds_read_b64_tr_b16 a[8:9], v5 offset:3648
ds_read_b64_tr_b16 a[10:11], v5 offset:4544
v_mfma_f32_32x32x16_bf16 v[64:79], a[40:43], a[60:63], v[64:79]
s_add_u32 s86, s85, 917504
s_add_u32 m0, s76, 57344
s_nop 0
buffer_load_dwordx4 v144, s[72:75], s86 offen lds
ds_read_b64_tr_b16 a[12:13], v5 offset:3680
ds_read_b64_tr_b16 a[14:15], v5 offset:4576
v_mfma_f32_32x32x16_bf16 v[80:95], a[44:47], a[60:63], v[80:95]
ds_read_b64_tr_b16 a[16:17], v5 offset:3712
ds_read_b64_tr_b16 a[18:19], v5 offset:4608
v_mfma_f32_32x32x16_bf16 v[96:111], a[48:51], a[60:63], v[96:111]
s_add_u32 s86, s85, 917504
s_add_u32 m0, s76, 58368
s_nop 0
buffer_load_dwordx4 v145, s[72:75], s86 offen lds
ds_read_b64_tr_b16 a[20:21], v5 offset:3744
ds_read_b64_tr_b16 a[22:23], v5 offset:4640
v_mfma_f32_32x32x16_bf16 v[112:127], a[52:55], a[60:63], v[112:127]
s_add_u32 s86, s85, 917504
s_add_u32 m0, s76, 59392
s_nop 0
buffer_load_dwordx4 v146, s[72:75], s86 offen lds
ds_read_b64_tr_b16 a[24:25], v5 offset:3776
ds_read_b64_tr_b16 a[26:27], v5 offset:4672
s_waitcnt lgkmcnt(0)
s_waitcnt vmcnt(8)
v_mfma_f32_32x32x16_bf16 v[16:31], a[0:3], a[64:67], v[16:31]
ds_read_b64_tr_b16 a[28:29], v5 offset:10752
ds_read_b64_tr_b16 a[30:31], v5 offset:11648
v_mfma_f32_32x32x16_bf16 v[32:47], a[4:7], a[64:67], v[32:47]
s_add_u32 s62, s62, 4096
buffer_load_dwordx4 a[56:59], v11, s[44:47], s62 offen offset:1024 sc1
ds_read_b64_tr_b16 a[32:33], v5 offset:10784
ds_read_b64_tr_b16 a[34:35], v5 offset:11680
v_mfma_f32_32x32x16_bf16 v[48:63], a[8:11], a[64:67], v[48:63]
ds_read_b64_tr_b16 a[36:37], v5 offset:10816
ds_read_b64_tr_b16 a[38:39], v5 offset:11712
v_mfma_f32_32x32x16_bf16 v[64:79], a[12:15], a[64:67], v[64:79]
s_add_u32 s86, s85, 917504
s_add_u32 m0, s76, 60416
s_nop 0
buffer_load_dwordx4 v147, s[72:75], s86 offen lds
ds_read_b64_tr_b16 a[40:41], v5 offset:10848
ds_read_b64_tr_b16 a[42:43], v5 offset:11744
v_mfma_f32_32x32x16_bf16 v[80:95], a[16:19], a[64:67], v[80:95]
ds_read_b64_tr_b16 a[44:45], v5 offset:10880
ds_read_b64_tr_b16 a[46:47], v5 offset:11776
v_mfma_f32_32x32x16_bf16 v[96:111], a[20:23], a[64:67], v[96:111]
s_add_u32 s86, s85, 917504
s_add_u32 m0, s76, 61440
s_nop 0
buffer_load_dwordx4 v148, s[72:75], s86 offen lds
ds_read_b64_tr_b16 a[48:49], v5 offset:10912
ds_read_b64_tr_b16 a[50:51], v5 offset:11808
v_mfma_f32_32x32x16_bf16 v[112:127], a[24:27], a[64:67], v[112:127]
s_add_u32 s86, s85, 917504
s_add_u32 m0, s76, 62464
s_nop 0
buffer_load_dwordx4 v149, s[72:75], s86 offen lds
ds_read_b64_tr_b16 a[52:53], v5 offset:10944
ds_read_b64_tr_b16 a[54:55], v5 offset:11840
s_waitcnt lgkmcnt(0)
s_waitcnt vmcnt(9)
s_barrier
s_waitcnt vmcnt(11)
v_mfma_f32_32x32x16_bf16 v[16:31], a[28:31], a[68:71], v[16:31]
ds_read_b64_tr_b16 a[0:1], v6 offset:3584
ds_read_b64_tr_b16 a[2:3], v6 offset:4480
v_mfma_f32_32x32x16_bf16 v[32:47], a[32:35], a[68:71], v[32:47]
buffer_load_dwordx4 a[60:63], v11, s[44:47], s62 offen offset:3072 sc1
ds_read_b64_tr_b16 a[4:5], v6 offset:3616
ds_read_b64_tr_b16 a[6:7], v6 offset:4512
v_mfma_f32_32x32x16_bf16 v[48:63], a[36:39], a[68:71], v[48:63]
ds_read_b64_tr_b16 a[8:9], v6 offset:3648
ds_read_b64_tr_b16 a[10:11], v6 offset:4544
v_mfma_f32_32x32x16_bf16 v[64:79], a[40:43], a[68:71], v[64:79]
s_add_u32 s86, s85, 917504
s_add_u32 m0, s76, 63488
s_nop 0
buffer_load_dwordx4 v150, s[72:75], s86 offen lds
ds_read_b64_tr_b16 a[12:13], v6 offset:3680
ds_read_b64_tr_b16 a[14:15], v6 offset:4576
v_mfma_f32_32x32x16_bf16 v[80:95], a[44:47], a[68:71], v[80:95]
ds_read_b64_tr_b16 a[16:17], v6 offset:3712
ds_read_b64_tr_b16 a[18:19], v6 offset:4608
v_mfma_f32_32x32x16_bf16 v[96:111], a[48:51], a[68:71], v[96:111]
ds_read_b64_tr_b16 a[20:21], v6 offset:3744
ds_read_b64_tr_b16 a[22:23], v6 offset:4640
v_mfma_f32_32x32x16_bf16 v[112:127], a[52:55], a[68:71], v[112:127]
ds_read_b64_tr_b16 a[24:25], v6 offset:3776
ds_read_b64_tr_b16 a[26:27], v6 offset:4672
s_waitcnt lgkmcnt(0)
s_waitcnt vmcnt(12)
v_mfma_f32_32x32x16_bf16 v[16:31], a[0:3], a[72:75], v[16:31]
ds_read_b64_tr_b16 a[28:29], v6 offset:10752
ds_read_b64_tr_b16 a[30:31], v6 offset:11648
v_mfma_f32_32x32x16_bf16 v[32:47], a[4:7], a[72:75], v[32:47]
s_add_u32 s62, s62, 4096
buffer_load_dwordx4 a[64:67], v11, s[44:47], s62 offen offset:1024 sc1
ds_read_b64_tr_b16 a[32:33], v6 offset:10784
ds_read_b64_tr_b16 a[34:35], v6 offset:11680
v_mfma_f32_32x32x16_bf16 v[48:63], a[8:11], a[72:75], v[48:63]
ds_read_b64_tr_b16 a[36:37], v6 offset:10816
ds_read_b64_tr_b16 a[38:39], v6 offset:11712
v_mfma_f32_32x32x16_bf16 v[64:79], a[12:15], a[72:75], v[64:79]
ds_read_b64_tr_b16 a[40:41], v6 offset:10848
ds_read_b64_tr_b16 a[42:43], v6 offset:11744
v_mfma_f32_32x32x16_bf16 v[80:95], a[16:19], a[72:75], v[80:95]
ds_read_b64_tr_b16 a[44:45], v6 offset:10880
ds_read_b64_tr_b16 a[46:47], v6 offset:11776
v_mfma_f32_32x32x16_bf16 v[96:111], a[20:23], a[72:75], v[96:111]
ds_read_b64_tr_b16 a[48:49], v6 offset:10912
ds_read_b64_tr_b16 a[50:51], v6 offset:11808
v_mfma_f32_32x32x16_bf16 v[112:127], a[24:27], a[72:75], v[112:127]
ds_read_b64_tr_b16 a[52:53], v6 offset:10944
ds_read_b64_tr_b16 a[54:55], v6 offset:11840
s_waitcnt lgkmcnt(0)
s_barrier
s_waitcnt vmcnt(12)
v_mfma_f32_32x32x16_bf16 v[16:31], a[28:31], a[76:79], v[16:31]
ds_read_b64_tr_b16 a[0:1], v7 offset:3584
ds_read_b64_tr_b16 a[2:3], v7 offset:4480
v_mfma_f32_32x32x16_bf16 v[32:47], a[32:35], a[76:79], v[32:47]
buffer_load_dwordx4 a[68:71], v11, s[44:47], s62 offen offset:3072 sc1
ds_read_b64_tr_b16 a[4:5], v7 offset:3616
ds_read_b64_tr_b16 a[6:7], v7 offset:4512
v_mfma_f32_32x32x16_bf16 v[48:63], a[36:39], a[76:79], v[48:63]
ds_read_b64_tr_b16 a[8:9], v7 offset:3648
ds_read_b64_tr_b16 a[10:11], v7 offset:4544
v_mfma_f32_32x32x16_bf16 v[64:79], a[40:43], a[76:79], v[64:79]
s_add_u32 s86, s85, 1376256
s_add_u32 m0, s76, 127104
s_nop 0
buffer_load_dwordx4 v144, s[72:75], s86 offen lds
ds_read_b64_tr_b16 a[12:13], v7 offset:3680
ds_read_b64_tr_b16 a[14:15], v7 offset:4576
v_mfma_f32_32x32x16_bf16 v[80:95], a[44:47], a[76:79], v[80:95]
ds_read_b64_tr_b16 a[16:17], v7 offset:3712
ds_read_b64_tr_b16 a[18:19], v7 offset:4608
v_mfma_f32_32x32x16_bf16 v[96:111], a[48:51], a[76:79], v[96:111]
s_add_u32 s86, s85, 1376256
s_add_u32 m0, s76, 128128
s_nop 0
buffer_load_dwordx4 v145, s[72:75], s86 offen lds
ds_read_b64_tr_b16 a[20:21], v7 offset:3744
ds_read_b64_tr_b16 a[22:23], v7 offset:4640
v_mfma_f32_32x32x16_bf16 v[112:127], a[52:55], a[76:79], v[112:127]
s_add_u32 s86, s85, 1376256
s_add_u32 m0, s76, 129152
s_nop 0
buffer_load_dwordx4 v146, s[72:75], s86 offen lds
ds_read_b64_tr_b16 a[24:25], v7 offset:3776
ds_read_b64_tr_b16 a[26:27], v7 offset:4672
s_waitcnt lgkmcnt(0)
s_waitcnt vmcnt(15)
v_mfma_f32_32x32x16_bf16 v[16:31], a[0:3], a[80:83], v[16:31]
ds_read_b64_tr_b16 a[28:29], v7 offset:10752
ds_read_b64_tr_b16 a[30:31], v7 offset:11648
v_mfma_f32_32x32x16_bf16 v[32:47], a[4:7], a[80:83], v[32:47]
s_add_u32 s62, s62, 4096
buffer_load_dwordx4 a[72:75], v11, s[44:47], s62 offen offset:1024 sc1
ds_read_b64_tr_b16 a[32:33], v7 offset:10784
ds_read_b64_tr_b16 a[34:35], v7 offset:11680
v_mfma_f32_32x32x16_bf16 v[48:63], a[8:11], a[80:83], v[48:63]
ds_read_b64_tr_b16 a[36:37], v7 offset:10816
ds_read_b64_tr_b16 a[38:39], v7 offset:11712
v_mfma_f32_32x32x16_bf16 v[64:79], a[12:15], a[80:83], v[64:79]
s_add_u32 s86, s85, 1376256
s_add_u32 m0, s76, 130176
s_nop 0
buffer_load_dwordx4 v147, s[72:75], s86 offen lds
ds_read_b64_tr_b16 a[40:41], v7 offset:10848
ds_read_b64_tr_b16 a[42:43], v7 offset:11744
v_mfma_f32_32x32x16_bf16 v[80:95], a[16:19], a[80:83], v[80:95]
ds_read_b64_tr_b16 a[44:45], v7 offset:10880
ds_read_b64_tr_b16 a[46:47], v7 offset:11776
v_mfma_f32_32x32x16_bf16 v[96:111], a[20:23], a[80:83], v[96:111]
s_add_u32 s86, s85, 1376256
s_add_u32 m0, s76, 131200
s_nop 0
buffer_load_dwordx4 v148, s[72:75], s86 offen lds
ds_read_b64_tr_b16 a[48:49], v7 offset:10912
ds_read_b64_tr_b16 a[50:51], v7 offset:11808
v_mfma_f32_32x32x16_bf16 v[112:127], a[24:27], a[80:83], v[112:127]
s_add_u32 s86, s85, 1376256
s_add_u32 m0, s76, 132224
s_nop 0
buffer_load_dwordx4 v149, s[72:75], s86 offen lds
ds_read_b64_tr_b16 a[52:53], v7 offset:10944
ds_read_b64_tr_b16 a[54:55], v7 offset:11840
s_waitcnt lgkmcnt(0)
s_waitcnt vmcnt(9)
s_barrier
s_waitcnt vmcnt(18)
v_mfma_f32_32x32x16_bf16 v[16:31], a[28:31], a[84:87], v[16:31]
ds_read_b64_tr_b16 a[0:1], v4 offset:3584
ds_read_b64_tr_b16 a[2:3], v4 offset:4480
v_mfma_f32_32x32x16_bf16 v[32:47], a[32:35], a[84:87], v[32:47]
buffer_load_dwordx4 a[76:79], v11, s[44:47], s62 offen offset:3072 sc1
ds_read_b64_tr_b16 a[4:5], v4 offset:3616
ds_read_b64_tr_b16 a[6:7], v4 offset:4512
v_mfma_f32_32x32x16_bf16 v[48:63], a[36:39], a[84:87], v[48:63]
ds_read_b64_tr_b16 a[8:9], v4 offset:3648
ds_read_b64_tr_b16 a[10:11], v4 offset:4544
v_mfma_f32_32x32x16_bf16 v[64:79], a[40:43], a[84:87], v[64:79]
s_add_u32 s86, s85, 1376256
s_add_u32 m0, s76, 133248
s_nop 0
buffer_load_dwordx4 v150, s[72:75], s86 offen lds
ds_read_b64_tr_b16 a[12:13], v4 offset:3680
ds_read_b64_tr_b16 a[14:15], v4 offset:4576
v_mfma_f32_32x32x16_bf16 v[80:95], a[44:47], a[84:87], v[80:95]
ds_read_b64_tr_b16 a[16:17], v4 offset:3712
ds_read_b64_tr_b16 a[18:19], v4 offset:4608
v_mfma_f32_32x32x16_bf16 v[96:111], a[48:51], a[84:87], v[96:111]
ds_read_b64_tr_b16 a[20:21], v4 offset:3744
ds_read_b64_tr_b16 a[22:23], v4 offset:4640
v_mfma_f32_32x32x16_bf16 v[112:127], a[52:55], a[84:87], v[112:127]
ds_read_b64_tr_b16 a[24:25], v4 offset:3776
ds_read_b64_tr_b16 a[26:27], v4 offset:4672
s_waitcnt lgkmcnt(0)
s_waitcnt vmcnt(16)
v_mfma_f32_32x32x16_bf16 v[16:31], a[0:3], a[56:59], v[16:31]
ds_read_b64_tr_b16 a[28:29], v4 offset:10752
ds_read_b64_tr_b16 a[30:31], v4 offset:11648
v_mfma_f32_32x32x16_bf16 v[32:47], a[4:7], a[56:59], v[32:47]
s_add_u32 s62, s62, 4096
buffer_load_dwordx4 a[80:83], v11, s[44:47], s62 offen offset:1024 sc1
ds_read_b64_tr_b16 a[32:33], v4 offset:10784
ds_read_b64_tr_b16 a[34:35], v4 offset:11680
v_mfma_f32_32x32x16_bf16 v[48:63], a[8:11], a[56:59], v[48:63]
ds_read_b64_tr_b16 a[36:37], v4 offset:10816
ds_read_b64_tr_b16 a[38:39], v4 offset:11712
v_mfma_f32_32x32x16_bf16 v[64:79], a[12:15], a[56:59], v[64:79]
ds_read_b64_tr_b16 a[40:41], v4 offset:10848
ds_read_b64_tr_b16 a[42:43], v4 offset:11744
v_mfma_f32_32x32x16_bf16 v[80:95], a[16:19], a[56:59], v[80:95]
ds_read_b64_tr_b16 a[44:45], v4 offset:10880
ds_read_b64_tr_b16 a[46:47], v4 offset:11776
v_mfma_f32_32x32x16_bf16 v[96:111], a[20:23], a[56:59], v[96:111]
ds_read_b64_tr_b16 a[48:49], v4 offset:10912
ds_read_b64_tr_b16 a[50:51], v4 offset:11808
v_mfma_f32_32x32x16_bf16 v[112:127], a[24:27], a[56:59], v[112:127]
ds_read_b64_tr_b16 a[52:53], v4 offset:10944
ds_read_b64_tr_b16 a[54:55], v4 offset:11840
s_waitcnt lgkmcnt(0)
s_barrier
s_waitcnt vmcnt(13)
v_mfma_f32_32x32x16_bf16 v[16:31], a[28:31], a[60:63], v[16:31]
ds_read_b64_tr_b16 a[0:1], v5 offset:3584
ds_read_b64_tr_b16 a[2:3], v5 offset:4480
v_mfma_f32_32x32x16_bf16 v[32:47], a[32:35], a[60:63], v[32:47]
buffer_load_dwordx4 a[84:87], v11, s[44:47], s62 offen offset:3072 sc1
ds_read_b64_tr_b16 a[4:5], v5 offset:3616
ds_read_b64_tr_b16 a[6:7], v5 offset:4512
v_mfma_f32_32x32x16_bf16 v[48:63], a[36:39], a[60:63], v[48:63]
ds_read_b64_tr_b16 a[8:9], v5 offset:3648
ds_read_b64_tr_b16 a[10:11], v5 offset:4544
v_mfma_f32_32x32x16_bf16 v[64:79], a[40:43], a[60:63], v[64:79]
s_mul_i32 s92, s49, 57344
s_lshl_b32 s93, s52, 13
s_add_u32 s92, s92, s93
buffer_load_dword v2, v10, s[28:31], s92 offen
ds_read_b64_tr_b16 a[12:13], v5 offset:3680
ds_read_b64_tr_b16 a[14:15], v5 offset:4576
v_mfma_f32_32x32x16_bf16 v[80:95], a[44:47], a[60:63], v[80:95]
ds_read_b64_tr_b16 a[16:17], v5 offset:3712
ds_read_b64_tr_b16 a[18:19], v5 offset:4608
v_mfma_f32_32x32x16_bf16 v[96:111], a[48:51], a[60:63], v[96:111]
ds_read_b64_tr_b16 a[20:21], v5 offset:3744
ds_read_b64_tr_b16 a[22:23], v5 offset:4640
v_mfma_f32_32x32x16_bf16 v[112:127], a[52:55], a[60:63], v[112:127]
ds_read_b64_tr_b16 a[24:25], v5 offset:3776
ds_read_b64_tr_b16 a[26:27], v5 offset:4672
s_waitcnt lgkmcnt(0)
s_waitcnt vmcnt(13)
v_mfma_f32_32x32x16_bf16 v[16:31], a[0:3], a[64:67], v[16:31]
ds_read_b64_tr_b16 a[28:29], v5 offset:10752
ds_read_b64_tr_b16 a[30:31], v5 offset:11648
v_mfma_f32_32x32x16_bf16 v[32:47], a[4:7], a[64:67], v[32:47]
ds_read_b64_tr_b16 a[32:33], v5 offset:10784
ds_read_b64_tr_b16 a[34:35], v5 offset:11680
v_mfma_f32_32x32x16_bf16 v[48:63], a[8:11], a[64:67], v[48:63]
ds_read_b64_tr_b16 a[36:37], v5 offset:10816
ds_read_b64_tr_b16 a[38:39], v5 offset:11712
v_mfma_f32_32x32x16_bf16 v[64:79], a[12:15], a[64:67], v[64:79]
ds_read_b64_tr_b16 a[40:41], v5 offset:10848
ds_read_b64_tr_b16 a[42:43], v5 offset:11744
v_mfma_f32_32x32x16_bf16 v[80:95], a[16:19], a[64:67], v[80:95]
ds_read_b64_tr_b16 a[44:45], v5 offset:10880
ds_read_b64_tr_b16 a[46:47], v5 offset:11776
v_mfma_f32_32x32x16_bf16 v[96:111], a[20:23], a[64:67], v[96:111]
ds_read_b64_tr_b16 a[48:49], v5 offset:10912
ds_read_b64_tr_b16 a[50:51], v5 offset:11808
v_mfma_f32_32x32x16_bf16 v[112:127], a[24:27], a[64:67], v[112:127]
ds_read_b64_tr_b16 a[52:53], v5 offset:10944
ds_read_b64_tr_b16 a[54:55], v5 offset:11840
s_waitcnt lgkmcnt(0)
s_waitcnt vmcnt(3)
s_barrier
s_waitcnt vmcnt(12)
v_mfma_f32_32x32x16_bf16 v[16:31], a[28:31], a[68:71], v[16:31]
ds_read_b64_tr_b16 a[0:1], v6 offset:3584
ds_read_b64_tr_b16 a[2:3], v6 offset:4480
v_mfma_f32_32x32x16_bf16 v[32:47], a[32:35], a[68:71], v[32:47]
ds_read_b64_tr_b16 a[4:5], v6 offset:3616
ds_read_b64_tr_b16 a[6:7], v6 offset:4512
v_mfma_f32_32x32x16_bf16 v[48:63], a[36:39], a[68:71], v[48:63]
ds_read_b64_tr_b16 a[8:9], v6 offset:3648
ds_read_b64_tr_b16 a[10:11], v6 offset:4544
v_mfma_f32_32x32x16_bf16 v[64:79], a[40:43], a[68:71], v[64:79]
ds_read_b64_tr_b16 a[12:13], v6 offset:3680
ds_read_b64_tr_b16 a[14:15], v6 offset:4576
v_mfma_f32_32x32x16_bf16 v[80:95], a[44:47], a[68:71], v[80:95]
ds_read_b64_tr_b16 a[16:17], v6 offset:3712
ds_read_b64_tr_b16 a[18:19], v6 offset:4608
v_mfma_f32_32x32x16_bf16 v[96:111], a[48:51], a[68:71], v[96:111]
ds_read_b64_tr_b16 a[20:21], v6 offset:3744
ds_read_b64_tr_b16 a[22:23], v6 offset:4640
v_mfma_f32_32x32x16_bf16 v[112:127], a[52:55], a[68:71], v[112:127]
ds_read_b64_tr_b16 a[24:25], v6 offset:3776
ds_read_b64_tr_b16 a[26:27], v6 offset:4672
s_waitcnt lgkmcnt(0)
s_waitcnt vmcnt(8)
v_mfma_f32_32x32x16_bf16 v[16:31], a[0:3], a[72:75], v[16:31]
ds_read_b64_tr_b16 a[28:29], v6 offset:10752
ds_read_b64_tr_b16 a[30:31], v6 offset:11648
v_mfma_f32_32x32x16_bf16 v[32:47], a[4:7], a[72:75], v[32:47]
ds_read_b64_tr_b16 a[32:33], v6 offset:10784
ds_read_b64_tr_b16 a[34:35], v6 offset:11680
v_mfma_f32_32x32x16_bf16 v[48:63], a[8:11], a[72:75], v[48:63]
ds_read_b64_tr_b16 a[36:37], v6 offset:10816
ds_read_b64_tr_b16 a[38:39], v6 offset:11712
v_mfma_f32_32x32x16_bf16 v[64:79], a[12:15], a[72:75], v[64:79]
ds_read_b64_tr_b16 a[40:41], v6 offset:10848
ds_read_b64_tr_b16 a[42:43], v6 offset:11744
v_mfma_f32_32x32x16_bf16 v[80:95], a[16:19], a[72:75], v[80:95]
ds_read_b64_tr_b16 a[44:45], v6 offset:10880
ds_read_b64_tr_b16 a[46:47], v6 offset:11776
v_mfma_f32_32x32x16_bf16 v[96:111], a[20:23], a[72:75], v[96:111]
ds_read_b64_tr_b16 a[48:49], v6 offset:10912
ds_read_b64_tr_b16 a[50:51], v6 offset:11808
v_mfma_f32_32x32x16_bf16 v[112:127], a[24:27], a[72:75], v[112:127]
ds_read_b64_tr_b16 a[52:53], v6 offset:10944
ds_read_b64_tr_b16 a[54:55], v6 offset:11840
s_waitcnt lgkmcnt(0)
s_barrier
s_waitcnt vmcnt(4)
v_mfma_f32_32x32x16_bf16 v[16:31], a[28:31], a[76:79], v[16:31]
ds_read_b64_tr_b16 a[0:1], v7 offset:3584
ds_read_b64_tr_b16 a[2:3], v7 offset:4480
v_mfma_f32_32x32x16_bf16 v[32:47], a[32:35], a[76:79], v[32:47]
s_add_u32 m0, s82, 127104
s_add_u32 s83, s81, 0
buffer_load_dwordx4 v152, s[28:31], s83 offen lds
ds_read_b64_tr_b16 a[4:5], v7 offset:3616
ds_read_b64_tr_b16 a[6:7], v7 offset:4512
v_mfma_f32_32x32x16_bf16 v[48:63], a[36:39], a[76:79], v[48:63]
ds_read_b64_tr_b16 a[8:9], v7 offset:3648
ds_read_b64_tr_b16 a[10:11], v7 offset:4544
v_mfma_f32_32x32x16_bf16 v[64:79], a[40:43], a[76:79], v[64:79]
s_add_u32 m0, s82, 135296
s_add_u32 s83, s81, 458752
buffer_load_dwordx4 v152, s[28:31], s83 offen lds
ds_read_b64_tr_b16 a[12:13], v7 offset:3680
ds_read_b64_tr_b16 a[14:15], v7 offset:4576
v_mfma_f32_32x32x16_bf16 v[80:95], a[44:47], a[76:79], v[80:95]
ds_read_b64_tr_b16 a[16:17], v7 offset:3712
ds_read_b64_tr_b16 a[18:19], v7 offset:4608
v_mfma_f32_32x32x16_bf16 v[96:111], a[48:51], a[76:79], v[96:111]
s_add_u32 m0, s82, 143488
s_add_u32 s83, s81, 917504
buffer_load_dwordx4 v152, s[28:31], s83 offen lds
ds_read_b64_tr_b16 a[20:21], v7 offset:3744
ds_read_b64_tr_b16 a[22:23], v7 offset:4640
v_mfma_f32_32x32x16_bf16 v[112:127], a[52:55], a[76:79], v[112:127]
ds_read_b64_tr_b16 a[24:25], v7 offset:3776
ds_read_b64_tr_b16 a[26:27], v7 offset:4672
s_waitcnt lgkmcnt(0)
s_waitcnt vmcnt(5)
v_mfma_f32_32x32x16_bf16 v[16:31], a[0:3], a[80:83], v[16:31]
ds_read_b64_tr_b16 a[28:29], v7 offset:10752
ds_read_b64_tr_b16 a[30:31], v7 offset:11648
v_mfma_f32_32x32x16_bf16 v[32:47], a[4:7], a[80:83], v[32:47]
s_add_u32 m0, s82, 151680
s_add_u32 s83, s81, 1376256
buffer_load_dwordx4 v152, s[28:31], s83 offen lds
ds_read_b64_tr_b16 a[32:33], v7 offset:10784
ds_read_b64_tr_b16 a[34:35], v7 offset:11680
v_mfma_f32_32x32x16_bf16 v[48:63], a[8:11], a[80:83], v[48:63]
ds_read_b64_tr_b16 a[36:37], v7 offset:10816
ds_read_b64_tr_b16 a[38:39], v7 offset:11712
v_mfma_f32_32x32x16_bf16 v[64:79], a[12:15], a[80:83], v[64:79]
ds_read_b64_tr_b16 a[40:41], v7 offset:10848
ds_read_b64_tr_b16 a[42:43], v7 offset:11744
v_mfma_f32_32x32x16_bf16 v[80:95], a[16:19], a[80:83], v[80:95]
ds_read_b64_tr_b16 a[44:45], v7 offset:10880
ds_read_b64_tr_b16 a[46:47], v7 offset:11776
v_mfma_f32_32x32x16_bf16 v[96:111], a[20:23], a[80:83], v[96:111]
ds_read_b64_tr_b16 a[48:49], v7 offset:10912
ds_read_b64_tr_b16 a[50:51], v7 offset:11808
v_mfma_f32_32x32x16_bf16 v[112:127], a[24:27], a[80:83], v[112:127]
ds_read_b64_tr_b16 a[52:53], v7 offset:10944
ds_read_b64_tr_b16 a[54:55], v7 offset:11840
s_waitcnt lgkmcnt(0)
s_waitcnt vmcnt(5)
v_mfma_f32_32x32x16_bf16 v[16:31], a[28:31], a[84:87], v[16:31]
v_mfma_f32_32x32x16_bf16 v[32:47], a[32:35], a[84:87], v[32:47]
v_mfma_f32_32x32x16_bf16 v[48:63], a[36:39], a[84:87], v[48:63]
v_mfma_f32_32x32x16_bf16 v[64:79], a[40:43], a[84:87], v[64:79]
v_mfma_f32_32x32x16_bf16 v[80:95], a[44:47], a[84:87], v[80:95]
v_mfma_f32_32x32x16_bf16 v[96:111], a[48:51], a[84:87], v[96:111]
v_mfma_f32_32x32x16_bf16 v[112:127], a[52:55], a[84:87], v[112:127]
s_mul_i32 s65, s57, 16384
s_add_u32 s65, s65, 0
v_add_u32 v12, s65, v11
s_mul_i32 s65, s57, 12288
s_add_u32 s65, s65, 65536
v_add_u32 v13, s65, v11
s_barrier
ds_write_b128 v12, v[16:19] offset:0
ds_write_b128 v12, v[20:23] offset:1024
ds_write_b128 v12, v[24:27] offset:2048
ds_write_b128 v12, v[28:31] offset:3072
ds_write_b128 v12, v[32:35] offset:4096
ds_write_b128 v12, v[36:39] offset:5120
ds_write_b128 v12, v[40:43] offset:6144
ds_write_b128 v12, v[44:47] offset:7168
ds_write_b128 v12, v[48:51] offset:8192
ds_write_b128 v12, v[52:55] offset:9216
ds_write_b128 v12, v[56:59] offset:10240
ds_write_b128 v12, v[60:63] offset:11264
ds_write_b128 v12, v[64:67] offset:12288
ds_write_b128 v12, v[68:71] offset:13312
ds_write_b128 v12, v[72:75] offset:14336
ds_write_b128 v12, v[76:79] offset:15360
v_mov_b32 v9, 0xbdd2d3e8
v_mov_b32 v8, 0xc0135761
s_lshl_b32 s65, s50, 2
s_add_u32 s65, s65, s57
s_mul_i32 s65, s65, 114688
s_mul_i32 s66, s51, 7168
s_add_u32 s65, s65, s66
s_lshl_b32 s66, s58, 12
s_add_u32 s65, s65, s66
s_add_u32 s65, s65, 10485760
s_lshl_b32 s66, s56, 5
s_lshl_b32 s67, s52, 2
s_add_u32 s66, s66, s67
s_add_u32 s66, s66, 163840
v_mov_b32 v14, s53
v_mov_b32 v15, 0
s_waitcnt lgkmcnt(0)
s_barrier
ds_read_b128 v[16:19], v13 offset:0
ds_read_b128 v[20:23], v13 offset:1024
ds_read_b128 v[24:27], v13 offset:2048
ds_read_b128 v[28:31], v13 offset:3072
ds_read_b128 v[32:35], v13 offset:4096
ds_read_b128 v[36:39], v13 offset:5120
ds_read_b128 v[40:43], v13 offset:6144
ds_read_b128 v[44:47], v13 offset:7168
ds_read_b128 v[48:51], v13 offset:8192
ds_read_b128 v[52:55], v13 offset:9216
ds_read_b128 v[56:59], v13 offset:10240
ds_read_b128 v[60:63], v13 offset:11264
s_waitcnt lgkmcnt(8)
v_pk_add_f32 v[80:81], v[80:81], v[16:17]
v_pk_add_f32 v[82:83], v[82:83], v[18:19]
v_pk_add_f32 v[84:85], v[84:85], v[20:21]
v_pk_add_f32 v[86:87], v[86:87], v[22:23]
v_pk_add_f32 v[88:89], v[88:89], v[24:25]
v_pk_add_f32 v[90:91], v[90:91], v[26:27]
v_pk_add_f32 v[92:93], v[92:93], v[28:29]
v_pk_add_f32 v[94:95], v[94:95], v[30:31]
v_pk_mul_f32 v[16:17], v[80:81], v[80:81]
v_pk_mul_f32 v[18:19], v[82:83], v[82:83]
v_pk_mul_f32 v[20:21], v[84:85], v[84:85]
v_pk_mul_f32 v[22:23], v[86:87], v[86:87]
v_pk_fma_f32 v[16:17], v[16:17], v[8:9], v[8:9] op_sel:[0,1,0] op_sel_hi:[1,1,0]
v_pk_fma_f32 v[18:19], v[18:19], v[8:9], v[8:9] op_sel:[0,1,0] op_sel_hi:[1,1,0]
v_pk_fma_f32 v[20:21], v[20:21], v[8:9], v[8:9] op_sel:[0,1,0] op_sel_hi:[1,1,0]
v_pk_fma_f32 v[22:23], v[22:23], v[8:9], v[8:9] op_sel:[0,1,0] op_sel_hi:[1,1,0]
v_pk_mul_f32 v[16:17], v[16:17], v[80:81]
v_pk_mul_f32 v[18:19], v[18:19], v[82:83]
v_pk_mul_f32 v[20:21], v[20:21], v[84:85]
v_pk_mul_f32 v[22:23], v[22:23], v[86:87]
v_exp_f32 v16, v16
v_exp_f32 v17, v17
v_exp_f32 v18, v18
v_exp_f32 v19, v19
v_exp_f32 v20, v20
v_exp_f32 v21, v21
v_exp_f32 v22, v22
v_exp_f32 v23, v23
v_pk_mul_f32 v[80:81], v[80:81], v[88:89]
v_pk_mul_f32 v[82:83], v[82:83], v[90:91]
v_pk_mul_f32 v[84:85], v[84:85], v[92:93]
v_pk_mul_f32 v[86:87], v[86:87], v[94:95]
v_add_f32 v16, 1.0, v16
v_add_f32 v17, 1.0, v17
v_add_f32 v18, 1.0, v18
v_add_f32 v19, 1.0, v19
v_add_f32 v20, 1.0, v20
v_add_f32 v21, 1.0, v21
v_add_f32 v22, 1.0, v22
v_add_f32 v23, 1.0, v23
v_rcp_f32 v16, v16
v_rcp_f32 v17, v17
v_rcp_f32 v18, v18
v_rcp_f32 v19, v19
v_rcp_f32 v20, v20
v_rcp_f32 v21, v21
v_rcp_f32 v22, v22
v_rcp_f32 v23, v23
v_pk_mul_f32 v[80:81], v[80:81], v[16:17]
v_pk_mul_f32 v[82:83], v[82:83], v[18:19]
v_pk_mul_f32 v[84:85], v[84:85], v[20:21]
v_pk_mul_f32 v[86:87], v[86:87], v[22:23]
v_cvt_pk_bf16_f32 v88, v80, v81
v_cvt_pk_bf16_f32 v89, v82, v83
v_cvt_pk_bf16_f32 v90, v84, v85
v_cvt_pk_bf16_f32 v91, v86, v87
buffer_store_dwordx4 v[88:91], v11, s[44:47], s65 offen offset:0 sc1
s_waitcnt lgkmcnt(4)
v_pk_add_f32 v[96:97], v[96:97], v[32:33]
v_pk_add_f32 v[98:99], v[98:99], v[34:35]
v_pk_add_f32 v[100:101], v[100:101], v[36:37]
v_pk_add_f32 v[102:103], v[102:103], v[38:39]
v_pk_add_f32 v[104:105], v[104:105], v[40:41]
v_pk_add_f32 v[106:107], v[106:107], v[42:43]
v_pk_add_f32 v[108:109], v[108:109], v[44:45]
v_pk_add_f32 v[110:111], v[110:111], v[46:47]
v_pk_mul_f32 v[32:33], v[96:97], v[96:97]
v_pk_mul_f32 v[34:35], v[98:99], v[98:99]
v_pk_mul_f32 v[36:37], v[100:101], v[100:101]
v_pk_mul_f32 v[38:39], v[102:103], v[102:103]
v_pk_fma_f32 v[32:33], v[32:33], v[8:9], v[8:9] op_sel:[0,1,0] op_sel_hi:[1,1,0]
v_pk_fma_f32 v[34:35], v[34:35], v[8:9], v[8:9] op_sel:[0,1,0] op_sel_hi:[1,1,0]
v_pk_fma_f32 v[36:37], v[36:37], v[8:9], v[8:9] op_sel:[0,1,0] op_sel_hi:[1,1,0]
v_pk_fma_f32 v[38:39], v[38:39], v[8:9], v[8:9] op_sel:[0,1,0] op_sel_hi:[1,1,0]
v_pk_mul_f32 v[32:33], v[32:33], v[96:97]
v_pk_mul_f32 v[34:35], v[34:35], v[98:99]
v_pk_mul_f32 v[36:37], v[36:37], v[100:101]
v_pk_mul_f32 v[38:39], v[38:39], v[102:103]
v_exp_f32 v32, v32
v_exp_f32 v33, v33
v_exp_f32 v34, v34
v_exp_f32 v35, v35
v_exp_f32 v36, v36
v_exp_f32 v37, v37
v_exp_f32 v38, v38
v_exp_f32 v39, v39
v_pk_mul_f32 v[96:97], v[96:97], v[104:105]
v_pk_mul_f32 v[98:99], v[98:99], v[106:107]
v_pk_mul_f32 v[100:101], v[100:101], v[108:109]
v_pk_mul_f32 v[102:103], v[102:103], v[110:111]
v_add_f32 v32, 1.0, v32
v_add_f32 v33, 1.0, v33
v_add_f32 v34, 1.0, v34
v_add_f32 v35, 1.0, v35
v_add_f32 v36, 1.0, v36
v_add_f32 v37, 1.0, v37
v_add_f32 v38, 1.0, v38
v_add_f32 v39, 1.0, v39
v_rcp_f32 v32, v32
v_rcp_f32 v33, v33
v_rcp_f32 v34, v34
v_rcp_f32 v35, v35
v_rcp_f32 v36, v36
v_rcp_f32 v37, v37
v_rcp_f32 v38, v38
v_rcp_f32 v39, v39
v_pk_mul_f32 v[96:97], v[96:97], v[32:33]
v_pk_mul_f32 v[98:99], v[98:99], v[34:35]
v_pk_mul_f32 v[100:101], v[100:101], v[36:37]
v_pk_mul_f32 v[102:103], v[102:103], v[38:39]
v_cvt_pk_bf16_f32 v104, v96, v97
v_cvt_pk_bf16_f32 v105, v98, v99
v_cvt_pk_bf16_f32 v106, v100, v101
v_cvt_pk_bf16_f32 v107, v102, v103
buffer_store_dwordx4 v[104:107], v11, s[44:47], s65 offen offset:1024 sc1
s_waitcnt lgkmcnt(0)
v_pk_add_f32 v[112:113], v[112:113], v[48:49]
v_pk_add_f32 v[114:115], v[114:115], v[50:51]
v_pk_add_f32 v[116:117], v[116:117], v[52:53]
v_pk_add_f32 v[118:119], v[118:119], v[54:55]
v_pk_add_f32 v[120:121], v[120:121], v[56:57]
v_pk_add_f32 v[122:123], v[122:123], v[58:59]
v_pk_add_f32 v[124:125], v[124:125], v[60:61]
v_pk_add_f32 v[126:127], v[126:127], v[62:63]
v_pk_mul_f32 v[48:49], v[112:113], v[112:113]
v_pk_mul_f32 v[50:51], v[114:115], v[114:115]
v_pk_mul_f32 v[52:53], v[116:117], v[116:117]
v_pk_mul_f32 v[54:55], v[118:119], v[118:119]
v_pk_fma_f32 v[48:49], v[48:49], v[8:9], v[8:9] op_sel:[0,1,0] op_sel_hi:[1,1,0]
v_pk_fma_f32 v[50:51], v[50:51], v[8:9], v[8:9] op_sel:[0,1,0] op_sel_hi:[1,1,0]
v_pk_fma_f32 v[52:53], v[52:53], v[8:9], v[8:9] op_sel:[0,1,0] op_sel_hi:[1,1,0]
v_pk_fma_f32 v[54:55], v[54:55], v[8:9], v[8:9] op_sel:[0,1,0] op_sel_hi:[1,1,0]
v_pk_mul_f32 v[48:49], v[48:49], v[112:113]
v_pk_mul_f32 v[50:51], v[50:51], v[114:115]
v_pk_mul_f32 v[52:53], v[52:53], v[116:117]
v_pk_mul_f32 v[54:55], v[54:55], v[118:119]
v_exp_f32 v48, v48
v_exp_f32 v49, v49
v_exp_f32 v50, v50
v_exp_f32 v51, v51
v_exp_f32 v52, v52
v_exp_f32 v53, v53
v_exp_f32 v54, v54
v_exp_f32 v55, v55
v_pk_mul_f32 v[112:113], v[112:113], v[120:121]
v_pk_mul_f32 v[114:115], v[114:115], v[122:123]
v_pk_mul_f32 v[116:117], v[116:117], v[124:125]
v_pk_mul_f32 v[118:119], v[118:119], v[126:127]
v_add_f32 v48, 1.0, v48
v_add_f32 v49, 1.0, v49
v_add_f32 v50, 1.0, v50
v_add_f32 v51, 1.0, v51
v_add_f32 v52, 1.0, v52
v_add_f32 v53, 1.0, v53
v_add_f32 v54, 1.0, v54
v_add_f32 v55, 1.0, v55
v_rcp_f32 v48, v48
v_rcp_f32 v49, v49
v_rcp_f32 v50, v50
v_rcp_f32 v51, v51
v_rcp_f32 v52, v52
v_rcp_f32 v53, v53
v_rcp_f32 v54, v54
v_rcp_f32 v55, v55
v_pk_mul_f32 v[112:113], v[112:113], v[48:49]
v_pk_mul_f32 v[114:115], v[114:115], v[50:51]
v_pk_mul_f32 v[116:117], v[116:117], v[52:53]
v_pk_mul_f32 v[118:119], v[118:119], v[54:55]
v_cvt_pk_bf16_f32 v120, v112, v113
v_cvt_pk_bf16_f32 v121, v114, v115
v_cvt_pk_bf16_f32 v122, v116, v117
v_cvt_pk_bf16_f32 v123, v118, v119
buffer_store_dwordx4 v[120:123], v11, s[44:47], s65 offen offset:2048 sc1
s_cmp_eq_u32 s55, 0
s_cbranch_scc1 Ssl_67
s_waitcnt vmcnt(0)
s_mov_b64 exec, 1
buffer_store_dword v14, v15, s[44:47], s66 offen
s_mov_b64 exec, -1
s_branch Sen_68
Ssl_67:
s_waitcnt vmcnt(0)
s_mov_b64 exec, 1
buffer_store_dword v14, v15, s[44:47], s66 offen sc1
s_mov_b64 exec, -1
Sen_68:
Lguj_60:
s_add_u32 s60, s89, 163840
s_lshr_b32 s65, s52, 1
s_mul_i32 s62, s88, 114688
s_mul_i32 s61, s65, 28672
s_add_u32 s62, s62, s61
s_add_u32 s62, s62, 10485760
s_lshl_b32 s61, s65, 13
v_add_u32 v154, s61, v154
v_add_u32 v155, s61, v155
v_add_u32 v140, 127104, v154
v_add_u32 v141, 127104, v155
v_add_u32 v142, 0, v154
v_add_u32 v143, 0, v155
v_add_u32 v144, 32768, v154
v_add_u32 v145, 32768, v155
v_add_u32 v146, 65536, v154
v_add_u32 v147, 65536, v155
s_barrier
s_add_u32 m0, s82, 0
s_add_u32 s83, s81, 65536
buffer_load_dwordx4 v152, s[28:31], s83 offen lds
s_add_u32 m0, s82, 8192
s_add_u32 s83, s81, 524288
buffer_load_dwordx4 v152, s[28:31], s83 offen lds
s_add_u32 m0, s82, 16384
s_add_u32 s83, s81, 983040
buffer_load_dwordx4 v152, s[28:31], s83 offen lds
s_add_u32 m0, s82, 24576
s_add_u32 s83, s81, 1441792
buffer_load_dwordx4 v152, s[28:31], s83 offen lds
s_add_u32 m0, s82, 32768
s_add_u32 s83, s81, 131072
buffer_load_dwordx4 v152, s[28:31], s83 offen lds
s_add_u32 m0, s82, 40960
s_add_u32 s83, s81, 589824
buffer_load_dwordx4 v152, s[28:31], s83 offen lds
s_add_u32 m0, s82, 49152
s_add_u32 s83, s81, 1048576
buffer_load_dwordx4 v152, s[28:31], s83 offen lds
s_add_u32 m0, s82, 57344
s_add_u32 s83, s81, 1507328
buffer_load_dwordx4 v152, s[28:31], s83 offen lds
s_add_u32 m0, s82, 65536
s_add_u32 s83, s81, 196608
buffer_load_dwordx4 v152, s[28:31], s83 offen lds
s_add_u32 m0, s82, 73728
s_add_u32 s83, s81, 655360
buffer_load_dwordx4 v152, s[28:31], s83 offen lds
s_add_u32 m0, s82, 81920
s_add_u32 s83, s81, 1114112
buffer_load_dwordx4 v152, s[28:31], s83 offen lds
s_add_u32 m0, s82, 90112
s_add_u32 s83, s81, 1572864
buffer_load_dwordx4 v152, s[28:31], s83 offen lds
ds_read_b64_tr_b16 v[48:49], v140 offset:0
ds_read_b64_tr_b16 v[50:51], v140 offset:512
ds_read_b64_tr_b16 v[52:53], v141 offset:0
ds_read_b64_tr_b16 v[54:55], v141 offset:512
s_mov_b32 s71, 0
P_69:
buffer_load_dword v15, v153, s[44:47], s60 offen sc1
s_add_u32 s71, s71, 1
s_cmp_gt_u32 s71, 400000
s_cbranch_scc1 Po_70
s_waitcnt vmcnt(0)
v_cmp_ne_u32 vcc, s53, v15
s_nop 0
s_cbranch_vccz Po_70
s_sleep 2
s_branch P_69
Po_70:
s_waitcnt vmcnt(0)
buffer_load_dwordx4 a[0:3], v11, s[44:47], s62 offen offset:0 sc1
buffer_load_dwordx4 a[4:7], v11, s[44:47], s62 offen offset:1024 sc1
buffer_load_dwordx4 a[8:11], v11, s[44:47], s62 offen offset:2048 sc1
buffer_load_dwordx4 a[12:15], v11, s[44:47], s62 offen offset:3072 sc1
s_add_u32 s62, s62, 4096
buffer_load_dwordx4 a[16:19], v11, s[44:47], s62 offen offset:0 sc1
buffer_load_dwordx4 a[20:23], v11, s[44:47], s62 offen offset:1024 sc1
buffer_load_dwordx4 a[24:27], v11, s[44:47], s62 offen offset:2048 sc1
buffer_load_dwordx4 a[28:31], v11, s[44:47], s62 offen offset:3072 sc1
s_add_u32 s62, s62, 4096
buffer_load_dwordx4 a[32:35], v11, s[44:47], s62 offen offset:0 sc1
buffer_load_dwordx4 a[36:39], v11, s[44:47], s62 offen offset:1024 sc1
buffer_load_dwordx4 a[40:43], v11, s[44:47], s62 offen offset:2048 sc1
buffer_load_dwordx4 a[44:47], v11, s[44:47], s62 offen offset:3072 sc1
s_add_u32 s62, s62, 4096
buffer_load_dwordx4 a[48:51], v11, s[44:47], s62 offen offset:0 sc1
buffer_load_dwordx4 a[52:55], v11, s[44:47], s62 offen offset:1024 sc1
buffer_load_dwordx4 a[56:59], v11, s[44:47], s62 offen offset:2048 sc1
buffer_load_dwordx4 a[60:63], v11, s[44:47], s62 offen offset:3072 sc1
s_waitcnt lgkmcnt(0)
s_waitcnt vmcnt(15)
v_mfma_f32_32x32x16_bf16 v[16:31], v[48:51], a[0:3], 0
ds_read_b64_tr_b16 v[56:57], v140 offset:2048
ds_read_b64_tr_b16 v[58:59], v140 offset:2560
v_mfma_f32_32x32x16_bf16 v[32:47], v[52:55], a[0:3], 0
ds_read_b64_tr_b16 v[60:61], v141 offset:2048
ds_read_b64_tr_b16 v[62:63], v141 offset:2560
s_add_u32 s62, s62, 4096
buffer_load_dwordx4 a[64:67], v11, s[44:47], s62 offen offset:0 sc1
s_waitcnt lgkmcnt(0)
s_waitcnt vmcnt(15)
v_mfma_f32_32x32x16_bf16 v[16:31], v[56:59], a[4:7], v[16:31]
ds_read_b64_tr_b16 v[48:49], v140 offset:4096
ds_read_b64_tr_b16 v[50:51], v140 offset:4608
v_mfma_f32_32x32x16_bf16 v[32:47], v[60:63], a[4:7], v[32:47]
ds_read_b64_tr_b16 v[52:53], v141 offset:4096
ds_read_b64_tr_b16 v[54:55], v141 offset:4608
buffer_load_dwordx4 a[68:71], v11, s[44:47], s62 offen offset:1024 sc1
s_waitcnt lgkmcnt(0)
s_waitcnt vmcnt(15)
v_mfma_f32_32x32x16_bf16 v[16:31], v[48:51], a[8:11], v[16:31]
ds_read_b64_tr_b16 v[56:57], v140 offset:6144
ds_read_b64_tr_b16 v[58:59], v140 offset:6656
v_mfma_f32_32x32x16_bf16 v[32:47], v[52:55], a[8:11], v[32:47]
ds_read_b64_tr_b16 v[60:61], v141 offset:6144
ds_read_b64_tr_b16 v[62:63], v141 offset:6656
buffer_load_dwordx4 a[72:75], v11, s[44:47], s62 offen offset:2048 sc1
s_waitcnt lgkmcnt(0)
s_waitcnt vmcnt(19)
s_barrier
s_waitcnt vmcnt(15)
v_mfma_f32_32x32x16_bf16 v[16:31], v[56:59], a[12:15], v[16:31]
ds_read_b64_tr_b16 v[48:49], v142 offset:0
ds_read_b64_tr_b16 v[50:51], v142 offset:512
v_mfma_f32_32x32x16_bf16 v[32:47], v[60:63], a[12:15], v[32:47]
ds_read_b64_tr_b16 v[52:53], v143 offset:0
ds_read_b64_tr_b16 v[54:55], v143 offset:512
buffer_load_dwordx4 a[76:79], v11, s[44:47], s62 offen offset:3072 sc1
s_add_u32 m0, s82, 127104
s_add_u32 s83, s81, 262144
buffer_load_dwordx4 v152, s[28:31], s83 offen lds
s_add_u32 m0, s82, 135296
s_add_u32 s83, s81, 720896
buffer_load_dwordx4 v152, s[28:31], s83 offen lds
s_waitcnt lgkmcnt(0)
s_waitcnt vmcnt(17)
v_mfma_f32_32x32x16_bf16 v[16:31], v[48:51], a[16:19], v[16:31]
ds_read_b64_tr_b16 v[56:57], v142 offset:2048
ds_read_b64_tr_b16 v[58:59], v142 offset:2560
v_mfma_f32_32x32x16_bf16 v[32:47], v[52:55], a[16:19], v[32:47]
ds_read_b64_tr_b16 v[60:61], v143 offset:2048
ds_read_b64_tr_b16 v[62:63], v143 offset:2560
s_add_u32 s62, s62, 4096
buffer_load_dwordx4 a[0:3], v11, s[44:47], s62 offen offset:0 sc1
s_add_u32 m0, s82, 143488
s_add_u32 s83, s81, 1179648
buffer_load_dwordx4 v152, s[28:31], s83 offen lds
s_add_u32 m0, s82, 151680
s_add_u32 s83, s81, 1638400
buffer_load_dwordx4 v152, s[28:31], s83 offen lds
s_waitcnt lgkmcnt(0)
s_waitcnt vmcnt(19)
v_mfma_f32_32x32x16_bf16 v[16:31], v[56:59], a[20:23], v[16:31]
ds_read_b64_tr_b16 v[48:49], v142 offset:4096
ds_read_b64_tr_b16 v[50:51], v142 offset:4608
v_mfma_f32_32x32x16_bf16 v[32:47], v[60:63], a[20:23], v[32:47]
ds_read_b64_tr_b16 v[52:53], v143 offset:4096
ds_read_b64_tr_b16 v[54:55], v143 offset:4608
buffer_load_dwordx4 a[4:7], v11, s[44:47], s62 offen offset:1024 sc1
s_waitcnt lgkmcnt(0)
s_waitcnt vmcnt(19)
v_mfma_f32_32x32x16_bf16 v[16:31], v[48:51], a[24:27], v[16:31]
ds_read_b64_tr_b16 v[56:57], v142 offset:6144
ds_read_b64_tr_b16 v[58:59], v142 offset:6656
v_mfma_f32_32x32x16_bf16 v[32:47], v[52:55], a[24:27], v[32:47]
ds_read_b64_tr_b16 v[60:61], v143 offset:6144
ds_read_b64_tr_b16 v[62:63], v143 offset:6656
buffer_load_dwordx4 a[8:11], v11, s[44:47], s62 offen offset:2048 sc1
s_waitcnt lgkmcnt(0)
s_waitcnt vmcnt(27)
s_barrier
s_waitcnt vmcnt(19)
v_mfma_f32_32x32x16_bf16 v[16:31], v[56:59], a[28:31], v[16:31]
ds_read_b64_tr_b16 v[48:49], v144 offset:0
ds_read_b64_tr_b16 v[50:51], v144 offset:512
v_mfma_f32_32x32x16_bf16 v[32:47], v[60:63], a[28:31], v[32:47]
ds_read_b64_tr_b16 v[52:53], v145 offset:0
ds_read_b64_tr_b16 v[54:55], v145 offset:512
buffer_load_dwordx4 a[12:15], v11, s[44:47], s62 offen offset:3072 sc1
s_add_u32 m0, s82, 0
s_add_u32 s83, s81, 327680
buffer_load_dwordx4 v152, s[28:31], s83 offen lds
s_add_u32 m0, s82, 8192
s_add_u32 s83, s81, 786432
buffer_load_dwordx4 v152, s[28:31], s83 offen lds
s_waitcnt lgkmcnt(0)
s_waitcnt vmcnt(21)
v_mfma_f32_32x32x16_bf16 v[16:31], v[48:51], a[32:35], v[16:31]
ds_read_b64_tr_b16 v[56:57], v144 offset:2048
ds_read_b64_tr_b16 v[58:59], v144 offset:2560
v_mfma_f32_32x32x16_bf16 v[32:47], v[52:55], a[32:35], v[32:47]
ds_read_b64_tr_b16 v[60:61], v145 offset:2048
ds_read_b64_tr_b16 v[62:63], v145 offset:2560
s_add_u32 s62, s62, 4096
buffer_load_dwordx4 a[16:19], v11, s[44:47], s62 offen offset:0 sc1
s_add_u32 m0, s82, 16384
s_add_u32 s83, s81, 1245184
buffer_load_dwordx4 v152, s[28:31], s83 offen lds
s_add_u32 m0, s82, 24576
s_add_u32 s83, s81, 1703936
buffer_load_dwordx4 v152, s[28:31], s83 offen lds
s_waitcnt lgkmcnt(0)
s_waitcnt vmcnt(23)
v_mfma_f32_32x32x16_bf16 v[16:31], v[56:59], a[36:39], v[16:31]
ds_read_b64_tr_b16 v[48:49], v144 offset:4096
ds_read_b64_tr_b16 v[50:51], v144 offset:4608
v_mfma_f32_32x32x16_bf16 v[32:47], v[60:63], a[36:39], v[32:47]
ds_read_b64_tr_b16 v[52:53], v145 offset:4096
ds_read_b64_tr_b16 v[54:55], v145 offset:4608
buffer_load_dwordx4 a[20:23], v11, s[44:47], s62 offen offset:1024 sc1
s_waitcnt lgkmcnt(0)
s_waitcnt vmcnt(23)
v_mfma_f32_32x32x16_bf16 v[16:31], v[48:51], a[40:43], v[16:31]
ds_read_b64_tr_b16 v[56:57], v144 offset:6144
ds_read_b64_tr_b16 v[58:59], v144 offset:6656
v_mfma_f32_32x32x16_bf16 v[32:47], v[52:55], a[40:43], v[32:47]
ds_read_b64_tr_b16 v[60:61], v145 offset:6144
ds_read_b64_tr_b16 v[62:63], v145 offset:6656
buffer_load_dwordx4 a[24:27], v11, s[44:47], s62 offen offset:2048 sc1
s_waitcnt lgkmcnt(0)
s_waitcnt vmcnt(35)
s_barrier
s_waitcnt vmcnt(23)
v_mfma_f32_32x32x16_bf16 v[16:31], v[56:59], a[44:47], v[16:31]
ds_read_b64_tr_b16 v[48:49], v146 offset:0
ds_read_b64_tr_b16 v[50:51], v146 offset:512
v_mfma_f32_32x32x16_bf16 v[32:47], v[60:63], a[44:47], v[32:47]
ds_read_b64_tr_b16 v[52:53], v147 offset:0
ds_read_b64_tr_b16 v[54:55], v147 offset:512
buffer_load_dwordx4 a[28:31], v11, s[44:47], s62 offen offset:3072 sc1
s_add_u32 m0, s82, 32768
s_add_u32 s83, s81, 393216
buffer_load_dwordx4 v152, s[28:31], s83 offen lds
s_add_u32 m0, s82, 40960
s_add_u32 s83, s81, 851968
buffer_load_dwordx4 v152, s[28:31], s83 offen lds
s_waitcnt lgkmcnt(0)
s_waitcnt vmcnt(25)
v_mfma_f32_32x32x16_bf16 v[16:31], v[48:51], a[48:51], v[16:31]
ds_read_b64_tr_b16 v[56:57], v146 offset:2048
ds_read_b64_tr_b16 v[58:59], v146 offset:2560
v_mfma_f32_32x32x16_bf16 v[32:47], v[52:55], a[48:51], v[32:47]
ds_read_b64_tr_b16 v[60:61], v147 offset:2048
ds_read_b64_tr_b16 v[62:63], v147 offset:2560
s_add_u32 m0, s82, 49152
s_add_u32 s83, s81, 1310720
buffer_load_dwordx4 v152, s[28:31], s83 offen lds
s_add_u32 m0, s82, 57344
s_add_u32 s83, s81, 1769472
buffer_load_dwordx4 v152, s[28:31], s83 offen lds
s_waitcnt lgkmcnt(0)
s_waitcnt vmcnt(26)
v_mfma_f32_32x32x16_bf16 v[16:31], v[56:59], a[52:55], v[16:31]
ds_read_b64_tr_b16 v[48:49], v146 offset:4096
ds_read_b64_tr_b16 v[50:51], v146 offset:4608
v_mfma_f32_32x32x16_bf16 v[32:47], v[60:63], a[52:55], v[32:47]
ds_read_b64_tr_b16 v[52:53], v147 offset:4096
ds_read_b64_tr_b16 v[54:55], v147 offset:4608
s_waitcnt lgkmcnt(0)
s_waitcnt vmcnt(25)
v_mfma_f32_32x32x16_bf16 v[16:31], v[48:51], a[56:59], v[16:31]
ds_read_b64_tr_b16 v[56:57], v146 offset:6144
ds_read_b64_tr_b16 v[58:59], v146 offset:6656
v_mfma_f32_32x32x16_bf16 v[32:47], v[52:55], a[56:59], v[32:47]
ds_read_b64_tr_b16 v[60:61], v147 offset:6144
ds_read_b64_tr_b16 v[62:63], v147 offset:6656
s_waitcnt lgkmcnt(0)
s_waitcnt vmcnt(15)
s_barrier
s_waitcnt vmcnt(24)
v_mfma_f32_32x32x16_bf16 v[16:31], v[56:59], a[60:63], v[16:31]
ds_read_b64_tr_b16 v[48:49], v140 offset:0
ds_read_b64_tr_b16 v[50:51], v140 offset:512
v_mfma_f32_32x32x16_bf16 v[32:47], v[60:63], a[60:63], v[32:47]
ds_read_b64_tr_b16 v[52:53], v141 offset:0
ds_read_b64_tr_b16 v[54:55], v141 offset:512
s_waitcnt lgkmcnt(0)
s_waitcnt vmcnt(23)
v_mfma_f32_32x32x16_bf16 v[16:31], v[48:51], a[64:67], v[16:31]
ds_read_b64_tr_b16 v[56:57], v140 offset:2048
ds_read_b64_tr_b16 v[58:59], v140 offset:2560
v_mfma_f32_32x32x16_bf16 v[32:47], v[52:55], a[64:67], v[32:47]
ds_read_b64_tr_b16 v[60:61], v141 offset:2048
ds_read_b64_tr_b16 v[62:63], v141 offset:2560
s_waitcnt lgkmcnt(0)
s_waitcnt vmcnt(22)
v_mfma_f32_32x32x16_bf16 v[16:31], v[56:59], a[68:71], v[16:31]
ds_read_b64_tr_b16 v[48:49], v140 offset:4096
ds_read_b64_tr_b16 v[50:51], v140 offset:4608
v_mfma_f32_32x32x16_bf16 v[32:47], v[60:63], a[68:71], v[32:47]
ds_read_b64_tr_b16 v[52:53], v141 offset:4096
ds_read_b64_tr_b16 v[54:55], v141 offset:4608
s_waitcnt lgkmcnt(0)
s_waitcnt vmcnt(21)
v_mfma_f32_32x32x16_bf16 v[16:31], v[48:51], a[72:75], v[16:31]
ds_read_b64_tr_b16 v[56:57], v140 offset:6144
ds_read_b64_tr_b16 v[58:59], v140 offset:6656
v_mfma_f32_32x32x16_bf16 v[32:47], v[52:55], a[72:75], v[32:47]
ds_read_b64_tr_b16 v[60:61], v141 offset:6144
ds_read_b64_tr_b16 v[62:63], v141 offset:6656
s_waitcnt lgkmcnt(0)
s_waitcnt vmcnt(7)
s_barrier
s_waitcnt vmcnt(20)
v_mfma_f32_32x32x16_bf16 v[16:31], v[56:59], a[76:79], v[16:31]
ds_read_b64_tr_b16 v[48:49], v142 offset:0
ds_read_b64_tr_b16 v[50:51], v142 offset:512
v_mfma_f32_32x32x16_bf16 v[32:47], v[60:63], a[76:79], v[32:47]
ds_read_b64_tr_b16 v[52:53], v143 offset:0
ds_read_b64_tr_b16 v[54:55], v143 offset:512
s_waitcnt lgkmcnt(0)
s_waitcnt vmcnt(17)
v_mfma_f32_32x32x16_bf16 v[16:31], v[48:51], a[0:3], v[16:31]
ds_read_b64_tr_b16 v[56:57], v142 offset:2048
ds_read_b64_tr_b16 v[58:59], v142 offset:2560
v_mfma_f32_32x32x16_bf16 v[32:47], v[52:55], a[0:3], v[32:47]
ds_read_b64_tr_b16 v[60:61], v143 offset:2048
ds_read_b64_tr_b16 v[62:63], v143 offset:2560
s_waitcnt lgkmcnt(0)
s_waitcnt vmcnt(14)
v_mfma_f32_32x32x16_bf16 v[16:31], v[56:59], a[4:7], v[16:31]
ds_read_b64_tr_b16 v[48:49], v142 offset:4096
ds_read_b64_tr_b16 v[50:51], v142 offset:4608
v_mfma_f32_32x32x16_bf16 v[32:47], v[60:63], a[4:7], v[32:47]
ds_read_b64_tr_b16 v[52:53], v143 offset:4096
ds_read_b64_tr_b16 v[54:55], v143 offset:4608
s_waitcnt lgkmcnt(0)
s_waitcnt vmcnt(13)
v_mfma_f32_32x32x16_bf16 v[16:31], v[48:51], a[8:11], v[16:31]
ds_read_b64_tr_b16 v[56:57], v142 offset:6144
ds_read_b64_tr_b16 v[58:59], v142 offset:6656
v_mfma_f32_32x32x16_bf16 v[32:47], v[52:55], a[8:11], v[32:47]
ds_read_b64_tr_b16 v[60:61], v143 offset:6144
ds_read_b64_tr_b16 v[62:63], v143 offset:6656
s_waitcnt lgkmcnt(0)
s_waitcnt vmcnt(0)
s_barrier
s_waitcnt vmcnt(12)
v_mfma_f32_32x32x16_bf16 v[16:31], v[56:59], a[12:15], v[16:31]
ds_read_b64_tr_b16 v[48:49], v144 offset:0
ds_read_b64_tr_b16 v[50:51], v144 offset:512
v_mfma_f32_32x32x16_bf16 v[32:47], v[60:63], a[12:15], v[32:47]
ds_read_b64_tr_b16 v[52:53], v145 offset:0
ds_read_b64_tr_b16 v[54:55], v145 offset:512
s_waitcnt lgkmcnt(0)
s_waitcnt vmcnt(9)
v_mfma_f32_32x32x16_bf16 v[16:31], v[48:51], a[16:19], v[16:31]
ds_read_b64_tr_b16 v[56:57], v144 offset:2048
ds_read_b64_tr_b16 v[58:59], v144 offset:2560
v_mfma_f32_32x32x16_bf16 v[32:47], v[52:55], a[16:19], v[32:47]
ds_read_b64_tr_b16 v[60:61], v145 offset:2048
ds_read_b64_tr_b16 v[62:63], v145 offset:2560
s_waitcnt lgkmcnt(0)
s_waitcnt vmcnt(6)
v_mfma_f32_32x32x16_bf16 v[16:31], v[56:59], a[20:23], v[16:31]
ds_read_b64_tr_b16 v[48:49], v144 offset:4096
ds_read_b64_tr_b16 v[50:51], v144 offset:4608
v_mfma_f32_32x32x16_bf16 v[32:47], v[60:63], a[20:23], v[32:47]
ds_read_b64_tr_b16 v[52:53], v145 offset:4096
ds_read_b64_tr_b16 v[54:55], v145 offset:4608
s_waitcnt lgkmcnt(0)
s_waitcnt vmcnt(5)
v_mfma_f32_32x32x16_bf16 v[16:31], v[48:51], a[24:27], v[16:31]
ds_read_b64_tr_b16 v[56:57], v144 offset:6144
ds_read_b64_tr_b16 v[58:59], v144 offset:6656
v_mfma_f32_32x32x16_bf16 v[32:47], v[52:55], a[24:27], v[32:47]
ds_read_b64_tr_b16 v[60:61], v145 offset:6144
ds_read_b64_tr_b16 v[62:63], v145 offset:6656
s_waitcnt lgkmcnt(0)
s_waitcnt vmcnt(4)
v_mfma_f32_32x32x16_bf16 v[16:31], v[56:59], a[28:31], v[16:31]
v_mfma_f32_32x32x16_bf16 v[32:47], v[60:63], a[28:31], v[32:47]
s_barrier
s_and_b32 s61, s52, 1
s_lshl_b32 s61, s61, 15
s_lshr_b32 s65, s52, 1
s_lshl_b32 s66, s65, 11
s_add_u32 s66, s66, s61
s_add_u32 s66, s66, 0
v_add_u32 v12, s66, v11
s_lshl_b32 s66, s65, 13
s_add_u32 s66, s66, s61
s_add_u32 s66, s66, 0
v_add_u32 v13, s66, v11
ds_write_b128 v12, v[16:19] offset:0
ds_write_b128 v12, v[20:23] offset:1024
ds_write_b128 v12, v[24:27] offset:8192
ds_write_b128 v12, v[28:31] offset:9216
ds_write_b128 v12, v[32:35] offset:16384
ds_write_b128 v12, v[36:39] offset:17408
ds_write_b128 v12, v[40:43] offset:24576
ds_write_b128 v12, v[44:47] offset:25600
s_waitcnt lgkmcnt(0)
s_barrier
ds_read_b128 v[16:19], v13 offset:0
ds_read_b128 v[20:23], v13 offset:1024
ds_read_b128 v[24:27], v13 offset:2048
ds_read_b128 v[28:31], v13 offset:3072
ds_read_b128 v[32:35], v13 offset:4096
ds_read_b128 v[36:39], v13 offset:5120
ds_read_b128 v[40:43], v13 offset:6144
ds_read_b128 v[44:47], v13 offset:7168
s_waitcnt lgkmcnt(0)
v_add_f32 v16, v16, v24
v_add_f32 v32, v32, v40
v_add_f32 v17, v17, v25
v_add_f32 v33, v33, v41
v_add_f32 v18, v18, v26
v_add_f32 v34, v34, v42
v_add_f32 v19, v19, v27
v_add_f32 v35, v35, v43
v_add_f32 v20, v20, v28
v_add_f32 v36, v36, v44
v_add_f32 v21, v21, v29
v_add_f32 v37, v37, v45
v_add_f32 v22, v22, v30
v_add_f32 v38, v38, v46
v_add_f32 v23, v23, v31
v_add_f32 v39, v39, v47
v_add_f32 v48, v16, v32
v_add_f32 v49, v17, v33
v_add_f32 v50, v18, v34
v_add_f32 v51, v19, v35
v_add_f32 v52, v20, v36
v_add_f32 v53, v21, v37
v_add_f32 v54, v22, v38
v_add_f32 v55, v23, v39
v_lshlrev_b32 v64, 16, v132
v_and_b32 v65, 0xffff0000, v132
v_lshlrev_b32 v66, 16, v133
v_and_b32 v67, 0xffff0000, v133
v_lshlrev_b32 v68, 16, v134
v_and_b32 v69, 0xffff0000, v134
v_lshlrev_b32 v70, 16, v135
v_and_b32 v71, 0xffff0000, v135
v_accvgpr_read_b32 v56, a88
v_accvgpr_read_b32 v57, a89
v_accvgpr_read_b32 v58, a90
v_accvgpr_read_b32 v59, a91
v_accvgpr_read_b32 v60, a92
v_accvgpr_read_b32 v61, a93
v_accvgpr_read_b32 v62, a94
v_accvgpr_read_b32 v63, a95
v_fmac_f32 v64, v56, v48
v_fmac_f32 v65, v57, v49
v_fmac_f32 v66, v58, v50
v_fmac_f32 v67, v59, v51
v_fmac_f32 v68, v60, v52
v_fmac_f32 v69, v61, v53
v_fmac_f32 v70, v62, v54
v_fmac_f32 v71, v63, v55
v_cvt_pk_bf16_f32 v32, v64, v65
v_cvt_pk_bf16_f32 v33, v66, v67
v_cvt_pk_bf16_f32 v34, v68, v69
v_cvt_pk_bf16_f32 v35, v70, v71
buffer_store_dwordx4 v[32:35], v151, s[40:43], s80 offen
s_cmp_lg_u32 s2, 0
s_cbranch_scc1 Lfin_71
s_cmp_lg_u32 s52, 7
s_cbranch_scc1 Lfin_71
s_cmp_eq_u32 s101, 1
s_cbranch_scc1 Lfin_71
v_lshlrev_b32 v12, 3, v1
v_add_u32 v12, 4, v12
s_mov_b32 s60, 4096
s_mov_b32 s71, 0
P_72:
buffer_load_dword v13, v12, s[44:47], s60 offen sc1
s_add_u32 s71, s71, 1
s_cmp_gt_u32 s71, 400000
s_cbranch_scc1 Po_73
s_waitcnt vmcnt(0)
v_cmp_ne_u32 vcc, s53, v13
s_nop 0
s_cbranch_vccz Po_73
s_sleep 2
s_branch P_72
Po_73:
s_waitcnt vmcnt(0)
v_lshlrev_b32 v12, 3, v1
v_add_u32 v12, 516, v12
s_mov_b32 s60, 4096
s_mov_b32 s71, 0
P_74:
buffer_load_dword v13, v12, s[44:47], s60 offen sc1
s_add_u32 s71, s71, 1
s_cmp_gt_u32 s71, 400000
s_cbranch_scc1 Po_75
s_waitcnt vmcnt(0)
v_cmp_ne_u32 vcc, s53, v13
s_nop 0
s_cbranch_vccz Po_75
s_sleep 2
s_branch P_74
Po_75:
s_waitcnt vmcnt(0)
v_lshlrev_b32 v12, 3, v1
v_add_u32 v12, 1028, v12
s_mov_b32 s60, 4096
s_mov_b32 s71, 0
P_76:
buffer_load_dword v13, v12, s[44:47], s60 offen sc1
s_add_u32 s71, s71, 1
s_cmp_gt_u32 s71, 400000
s_cbranch_scc1 Po_77
s_waitcnt vmcnt(0)
v_cmp_ne_u32 vcc, s53, v13
s_nop 0
s_cbranch_vccz Po_77
s_sleep 2
s_branch P_76
Po_77:
s_waitcnt vmcnt(0)
v_lshlrev_b32 v12, 3, v1
v_add_u32 v12, 1540, v12
s_mov_b32 s60, 4096
s_mov_b32 s71, 0
P_78:
buffer_load_dword v13, v12, s[44:47], s60 offen sc1
s_add_u32 s71, s71, 1
s_cmp_gt_u32 s71, 400000
s_cbranch_scc1 Po_79
s_waitcnt vmcnt(0)
v_cmp_ne_u32 vcc, s53, v13
s_nop 0
s_cbranch_vccz Po_79
s_sleep 2
s_branch P_78
Po_79:
s_waitcnt vmcnt(0)
v_mov_b32 v14, s53
v_mov_b32 v15, 0
s_mov_b64 exec, 1
buffer_store_dword v14, v15, s[44:47], 0 offen offset:0 sc1
Lfin_71:
L_END:
s_endpgm
L_CODE_END:
.section .rodata,"a"
.p2align 6
.amdhsa_kernel adaLN_cond__sliding_block__geglu_ffn__prompt_kernel
  .amdhsa_next_free_vgpr 256
  .amdhsa_next_free_sgpr 102
  .amdhsa_accum_offset 160
  .amdhsa_group_segment_fixed_size 0
  .amdhsa_kernarg_size 96
  .amdhsa_user_sgpr_count 2
  .amdhsa_user_sgpr_kernarg_segment_ptr 1
  .amdhsa_system_sgpr_workgroup_id_x 1
.end_amdhsa_kernel
```
